```python
import torch

def _softmax(x, axis=-1):
    return torch.softmax(x, dim=axis)
def _gelu(x):
    return torch.nn.functional.gelu(x, approximate="tanh")
def _silu(x):
    return torch.nn.functional.silu(x)
def _sigmoid(x):
    return torch.sigmoid(x)
def _layernorm(x, axis=-1, eps=1e-5):
    m = x.mean(dim=axis, keepdim=True)
    v = x.var(dim=axis, keepdim=True, unbiased=False)
    return (x - m) / torch.sqrt(v + eps)
def _scatter_add(tgt, idx, src, axis=0):
    return tgt.clone().index_add_(axis, idx, src)
def _segment_sum(src, seg, n):
    out = torch.zeros((n,) + src.shape[1:], dtype=src.dtype)
    return out.index_add_(0, seg, src)
def _pad(x, pw):
    flat = tuple(v for pair in reversed(pw) for v in pair)
    return torch.nn.functional.pad(x, flat)

kernel_name = 'parallel_sum__softmax_full_mha__glu_gated_reglu__prompt'

def setup_inputs():

    _w = (lambda a: (lambda t: t.to(torch.bfloat16) if t.is_floating_point() else t)(torch.as_tensor(a)))
    def _A_setup():
        B, S, D = 1, 2048, 448
        return {
            "x": _w((lambda *s: torch.randn(*s, dtype=torch.bfloat16) * 0.05)(B, S, D)),
            "wqkv": _w((lambda *s: torch.randn(*s, dtype=torch.bfloat16) * 0.05)(D, 3 * D)),
            "wo": _w((lambda *s: torch.randn(*s, dtype=torch.bfloat16) * 0.05)(D, D)),
        }
    _A_in = _A_setup()

    def _B_setup():
        B, S, D, F = 1, 2048, 448, 1792
        return {
            "x": _w((lambda *s: torch.randn(*s, dtype=torch.bfloat16) * 0.05)(B, S, D)),
            "W_gate": _w((lambda *s: torch.randn(*s, dtype=torch.bfloat16) * 0.4)(D, F) * (2.0 / D) ** 0.5),
            "W_up": _w((lambda *s: torch.randn(*s, dtype=torch.bfloat16) * 0.4)(D, F) * (2.0 / D) ** 0.5),
            "W_down": _w((lambda *s: torch.randn(*s, dtype=torch.bfloat16) * 0.4)(F, D) * (1.0 / F) ** 0.5),
        }
    _B_in = _B_setup()

    return {
        "A_x": _A_in["x"],
        "A_wqkv": _A_in["wqkv"],
        "A_wo": _A_in["wo"],
        "B_x": _B_in["x"],
        "B_W_gate": _B_in["W_gate"],
        "B_W_up": _B_in["W_up"],
        "B_W_down": _B_in["W_down"],
    }

def reference(A_x, A_wqkv, A_wo, B_x, B_W_gate, B_W_up, B_W_down):
    def _A_ref(x, wqkv, wo):
        B, S, D = x.shape
        H = 16; Dh = D // H
        qkv = (lambda x, *d: x.permute(*d))((x @ wqkv).reshape(B, S, 3, H, Dh), 2, 0, 3, 1, 4)
        q, k, v = qkv[0], qkv[1], qkv[2]
        scale = Dh ** -0.5
        scores = torch.einsum("bhqd,bhkd->bhqk", q, k) * scale
        p = _softmax(scores, axis=-1)
        o = torch.einsum("bhqk,bhkd->bhqd", p, v)
        return (lambda x, *d: x.permute(*d))(o, 0, 2, 1, 3).reshape(B, S, D) @ wo

    def _B_ref(x, W_gate, W_up, W_down):
        gate = torch.einsum("bsd,df->bsf", x, W_gate)
        up = torch.einsum("bsd,df->bsf", x, W_up)
        gate = gate * (lambda x, dt: x.to(dt))(gate > 0, gate.dtype)
        h = gate * up
        return torch.einsum("bsf,fd->bsd", h, W_down)

    x = A_x
    xn = _layernorm(x, axis=-1)
    return x + _A_ref(xn, A_wqkv, A_wo) + _B_ref(xn, B_W_gate, B_W_up, B_W_down)
```

```asm
; @launch grid=(256,1,1) block=(512,1,1) lds=163840
.amdgcn_target "amdgcn-amd-amdhsa--gfx950"
.text
.globl parallel_sum__softmax_full_mha__glu_gated_reglu__prompt_kernel
.p2align 8
.type parallel_sum__softmax_full_mha__glu_gated_reglu__prompt_kernel,@function
parallel_sum__softmax_full_mha__glu_gated_reglu__prompt_kernel:
    s_cmp_ge_u32 s2, 256
    s_cbranch_scc1 L_end
    s_load_dwordx8 s[4:11], s[0:1], 0
    s_load_dwordx8 s[12:19], s[0:1], 32
    s_load_dwordx4 s[20:23], s[0:1], 64
    s_getpc_b64 s[56:57]
L_pc:
    v_lshrrev_b32 v1, 5, v0
    s_lshr_b32 s55, s2, 3
    s_lshl_b32 s55, s55, 4
    v_add_u32 v2, s55, v1
    v_lshlrev_b32_e64 v2, 7, v2
    v_min_u32 v2, L_code_end-L_pc-4, v2
    global_load_dword v255, v2, s[56:57]
    v_lshrrev_b32 v1, 6, v0
    v_and_b32 v0, 63, v0
    v_readfirstlane_b32 s63, v1
    s_and_b32 s48, s2, 7
    s_lshr_b32 s47, s2, 3
    s_lshr_b32 s50, s47, 2
    s_and_b32 s51, s47, 3
    s_and_b32 s44, s63, 3
    s_cmp_lt_u32 s63, 4
    s_cbranch_scc1 L_compute
    s_setprio 1
    s_and_b32 s46, s48, 1
    s_lshl_b32 s46, s46, 3
    s_add_u32 s46, s46, s50
    s_lshr_b32 s45, s48, 1
    s_lshl_b32 s45, s45, 2
    s_add_u32 s45, s45, s51
    s_lshl_b32 s49, s48, 2
    s_add_u32 s49, s49, s51
    s_lshl_b32 s3, s51, 1
    s_add_u32 s64, s3, s50
    s_cmp_ge_u32 s64, 7
    s_cselect_b32 s62, 7, 0
    s_sub_u32 s64, s64, s62
    s_cmp_ge_u32 s50, 7
    s_cselect_b32 s3, 3, s50
    s_lshl_b32 s52, s45, 2
    s_add_u32 s52, s52, s44
    v_lshrrev_b32 v174, 3, v0
    s_lshl_b32 s51, s52, 5
    v_add_u32_e64 v174, s51, v174
    v_mul_u32_u24 v174, 896, v174
    v_lshrrev_b32 v175, 4, v0
    v_and_b32 v176, 7, v0
    v_xor_b32_e64 v175, v175, v176
    v_lshl_add_u32 v160, v175, 4, v174
    v_xor_b32_e64 v175, 64, v160
    v_add_u32 v161, 6144, v175
    v_add_u32 v162, 12288, v160
    v_add_u32 v163, 18432, v175
    s_mul_i32 s53, s44, 28672
    s_add_u32 s53, s53, 49152
    s_lshl_b32 s55, s3, 7
    s_mov_b32 s30, 1835008
    s_mov_b32 s31, 0x00020000
    s_mov_b32 m0, s53
    s_waitcnt lgkmcnt(0)
    s_mov_b32 s28, s4
    s_mov_b32 s29, s5
    s_nop 0
    buffer_load_dwordx4 v160, s[28:31], s55 offen offset:0 lds
    buffer_load_dwordx4 v161, s[28:31], s55 offen offset:1024 lds
    buffer_load_dwordx4 v162, s[28:31], s55 offen offset:2048 lds
    buffer_load_dwordx4 v163, s[28:31], s55 offen offset:3072 lds
    s_add_u32 m0, s53, 4096
    s_add_u32 s55, s55, 128
    s_cmp_ge_u32 s55, 896
    s_cselect_b32 s55, 0, s55
    s_nop 0
    buffer_load_dwordx4 v160, s[28:31], s55 offen offset:0 lds
    buffer_load_dwordx4 v161, s[28:31], s55 offen offset:1024 lds
    buffer_load_dwordx4 v162, s[28:31], s55 offen offset:2048 lds
    buffer_load_dwordx4 v163, s[28:31], s55 offen offset:3072 lds
    s_add_u32 m0, s53, 8192
    s_add_u32 s55, s55, 128
    s_cmp_ge_u32 s55, 896
    s_cselect_b32 s55, 0, s55
    s_nop 0
    buffer_load_dwordx4 v160, s[28:31], s55 offen offset:0 lds
    buffer_load_dwordx4 v161, s[28:31], s55 offen offset:1024 lds
    buffer_load_dwordx4 v162, s[28:31], s55 offen offset:2048 lds
    buffer_load_dwordx4 v163, s[28:31], s55 offen offset:3072 lds
    s_add_u32 m0, s53, 12288
    s_add_u32 s55, s55, 128
    s_cmp_ge_u32 s55, 896
    s_cselect_b32 s55, 0, s55
    s_mov_b32 s24, s22
    s_mov_b32 s25, s23
    s_mov_b32 s26, 16875520
    s_mov_b32 s27, 0x00020000
    s_mul_i32 s56, s44, 28672
    s_add_u32 s56, s56, 49152
    v_and_b32 v172, 31, v0
    v_lshlrev_b32 v173, 7, v172
    v_add_u32 v173, s56, v173
    v_bfe_u32 v172, v0, 1, 3
    v_lshrrev_b32 v174, 5, v0
    v_xor_b32 v172, v172, v174
    v_lshl_add_u32 v164, v172, 4, v173
    v_xor_b32 v165, 32, v164
    v_xor_b32 v166, 64, v164
    v_xor_b32 v167, 96, v164
    v_mov_b32 v144, 0
    v_mov_b32 v145, 0
    v_mov_b32 v146, 0
    v_mov_b32 v147, 0
    v_mov_b32_e64 v182, 0
    v_mov_b32 v180, 0x3f803f80
    s_mov_b32 s61, 0xffff0000
    v_mov_b32_e64 v4, 1
    v_mov_b32 v3, 106368
    v_lshlrev_b32 v7, 4, v0
    v_and_b32 v181, 31, v0
    v_cmp_eq_u32_e64 vcc, 28, v181
    v_lshl_add_u32 v181, v181, 2, v3
    s_cmp_ge_u32 s46, 8
    s_cselect_b32 s62, 0xc9888d99, 0
    s_xor_b32 s62, s62, 0x67543210
    s_lshl_b32 s60, s46, 2
    s_lshr_b32 s60, s62, s60
    s_and_b32 s60, s60, 15
    v_cndmask_b32 v6, 0, v180, vcc
    v_lshrrev_b32 v177, 5, v0
    v_bfe_u32 v174, v0, 2, 2
    v_lshl_add_u32 v174, v177, 3, v174
    v_and_b32_e64 v175, 3, v0
    v_bfe_u32 v176, v0, 4, 1
    v_mul_u32_u24 v177, 224, v174
    v_lshl_add_u32 v177, v175, 3, v177
    v_mul_u32_u24 v178, 14464, v176
    v_add_u32_e64 v1, v177, v178
    v_mul_u32_u24 v178, 57472, v176
    v_add_u32 v177, 49024, v177
    v_add_u32_e64 v2, v177, v178
    v_mul_u32_u24 v177, 192, v174
    v_lshl_add_u32 v177, v175, 3, v177
    v_lshl_add_u32 v177, v176, 5, v177
    s_and_b32 s51, s60, 1
    s_lshl_b32 s51, s51, 3
    v_add_u32_e64 v168, s51, v177
    v_add_u32 v169, 49152, v168
    v_add_u32 v170, 106496, v168
    s_mul_i32 s54, s60, 3
    s_add_u32 s51, s54, 0
    s_lshr_b32 s62, s51, 4
    s_and_b32 s51, s51, 15
    s_lshl_b32 s51, s51, 6
    s_add_u32 s51, s51, s52
    s_lshl_b32 s56, s51, 11
    s_lshl_b32 s57, s51, 12
    s_lshl_b32 s58, s62, 11
    s_add_u32 s57, s57, s58
    s_add_u32 s57, s57, 2095104
    s_cmp_eq_u32 s62, 0
    s_cselect_b32 s32, s56, s57
    s_cselect_b32 s35, 0x3e8b97f6, 1.0
    s_add_u32 s51, s54, 1
    s_lshr_b32 s62, s51, 4
    s_and_b32 s51, s51, 15
    s_lshl_b32 s51, s51, 6
    s_add_u32 s51, s51, s52
    s_lshl_b32 s56, s51, 11
    s_lshl_b32 s57, s51, 12
    s_lshl_b32 s58, s62, 11
    s_add_u32 s57, s57, s58
    s_add_u32 s57, s57, 2095104
    s_cmp_eq_u32 s62, 0
    s_cselect_b32 s33, s56, s57
    s_cselect_b32 s36, 0x3e8b97f6, 1.0
    s_add_u32 s51, s54, 2
    s_lshr_b32 s62, s51, 4
    s_and_b32 s51, s51, 15
    s_lshl_b32 s51, s51, 6
    s_add_u32 s51, s51, s52
    s_lshl_b32 s56, s51, 11
    s_lshl_b32 s57, s51, 12
    s_lshl_b32 s58, s62, 11
    s_add_u32 s57, s57, s58
    s_add_u32 s57, s57, 2095104
    s_cmp_eq_u32 s62, 0
    s_cselect_b32 s34, s56, s57
    s_cselect_b32 s37, 0x3e8b97f6, 1.0
    s_mov_b32 s42, 0
    s_mov_b32 s43, -1
    s_mov_b32 s38, 0x0fffffff
    s_mov_b32 s39, 0x0fffffff
    buffer_load_dwordx4 v160, s[28:31], s55 offen offset:0 lds
    buffer_load_dwordx4 v161, s[28:31], s55 offen offset:1024 lds
    buffer_load_dwordx4 v162, s[28:31], s55 offen offset:2048 lds
    buffer_load_dwordx4 v163, s[28:31], s55 offen offset:3072 lds
    s_add_u32 m0, s53, 16384
    s_add_u32 s55, s55, 128
    s_cmp_ge_u32 s55, 896
    s_cselect_b32 s55, 0, s55
    s_waitcnt vmcnt(12)
    ds_read_b128 v[16:19], v164 offset:0
    ds_read_b128 v[20:23], v165 offset:0
    ds_read_b128 v[24:27], v166 offset:0
    ds_read_b128 v[28:31], v167 offset:0
    buffer_load_dwordx4 v160, s[28:31], s55 offen offset:0 lds
    buffer_load_dwordx4 v161, s[28:31], s55 offen offset:1024 lds
    buffer_load_dwordx4 v162, s[28:31], s55 offen offset:2048 lds
    buffer_load_dwordx4 v163, s[28:31], s55 offen offset:3072 lds
    s_add_u32 m0, s53, 20480
    s_add_u32 s55, s55, 128
    s_cmp_ge_u32 s55, 896
    s_cselect_b32 s55, 0, s55
    s_waitcnt vmcnt(12)
    ds_read_b128 v[32:35], v164 offset:4096
    ds_read_b128 v[36:39], v165 offset:4096
    ds_read_b128 v[40:43], v166 offset:4096
    ds_read_b128 v[44:47], v167 offset:4096
    buffer_load_dwordx4 v160, s[28:31], s55 offen offset:0 lds
    buffer_load_dwordx4 v161, s[28:31], s55 offen offset:1024 lds
    buffer_load_dwordx4 v162, s[28:31], s55 offen offset:2048 lds
    buffer_load_dwordx4 v163, s[28:31], s55 offen offset:3072 lds
    s_add_u32 m0, s53, 24576
    s_add_u32 s55, s55, 128
    s_cmp_ge_u32 s55, 896
    s_cselect_b32 s55, 0, s55
    s_waitcnt lgkmcnt(4)
    v_dot2c_f32_bf16 v144, v16, v180
    v_dot2c_f32_bf16 v146, v16, v16
    v_dot2c_f32_bf16 v145, v17, v180
    v_dot2c_f32_bf16 v147, v17, v17
    v_dot2c_f32_bf16 v144, v18, v180
    v_dot2c_f32_bf16 v146, v18, v18
    v_dot2c_f32_bf16 v145, v19, v180
    v_dot2c_f32_bf16 v147, v19, v19
    v_dot2c_f32_bf16 v144, v20, v180
    v_dot2c_f32_bf16 v146, v20, v20
    v_dot2c_f32_bf16 v145, v21, v180
    v_dot2c_f32_bf16 v147, v21, v21
    v_dot2c_f32_bf16 v144, v22, v180
    v_dot2c_f32_bf16 v146, v22, v22
    v_dot2c_f32_bf16 v145, v23, v180
    v_dot2c_f32_bf16 v147, v23, v23
    v_dot2c_f32_bf16 v144, v24, v180
    v_dot2c_f32_bf16 v146, v24, v24
    v_dot2c_f32_bf16 v145, v25, v180
    v_dot2c_f32_bf16 v147, v25, v25
    v_dot2c_f32_bf16 v144, v26, v180
    v_dot2c_f32_bf16 v146, v26, v26
    v_dot2c_f32_bf16 v145, v27, v180
    v_dot2c_f32_bf16 v147, v27, v27
    v_dot2c_f32_bf16 v144, v28, v180
    v_dot2c_f32_bf16 v146, v28, v28
    v_dot2c_f32_bf16 v145, v29, v180
    v_dot2c_f32_bf16 v147, v29, v29
    v_dot2c_f32_bf16 v144, v30, v180
    v_dot2c_f32_bf16 v146, v30, v30
    v_dot2c_f32_bf16 v145, v31, v180
    v_dot2c_f32_bf16 v147, v31, v31
    s_waitcnt vmcnt(12)
    s_nop 0
    ds_read_b128 v[48:51], v164 offset:8192
    ds_read_b128 v[52:55], v165 offset:8192
    ds_read_b128 v[56:59], v166 offset:8192
    ds_read_b128 v[60:63], v167 offset:8192
    buffer_load_dwordx4 v160, s[28:31], s55 offen offset:0 lds
    buffer_load_dwordx4 v161, s[28:31], s55 offen offset:1024 lds
    buffer_load_dwordx4 v162, s[28:31], s55 offen offset:2048 lds
    buffer_load_dwordx4 v163, s[28:31], s55 offen offset:3072 lds
    s_barrier
    s_waitcnt lgkmcnt(4)
    v_dot2c_f32_bf16 v144, v32, v180
    v_dot2c_f32_bf16 v146, v32, v32
    v_dot2c_f32_bf16 v145, v33, v180
    v_dot2c_f32_bf16 v147, v33, v33
    v_dot2c_f32_bf16 v144, v34, v180
    v_dot2c_f32_bf16 v146, v34, v34
    v_dot2c_f32_bf16 v145, v35, v180
    v_dot2c_f32_bf16 v147, v35, v35
    v_dot2c_f32_bf16 v144, v36, v180
    v_dot2c_f32_bf16 v146, v36, v36
    v_dot2c_f32_bf16 v145, v37, v180
    v_dot2c_f32_bf16 v147, v37, v37
    v_dot2c_f32_bf16 v144, v38, v180
    v_dot2c_f32_bf16 v146, v38, v38
    v_dot2c_f32_bf16 v145, v39, v180
    v_dot2c_f32_bf16 v147, v39, v39
    v_dot2c_f32_bf16 v144, v40, v180
    v_dot2c_f32_bf16 v146, v40, v40
    v_dot2c_f32_bf16 v145, v41, v180
    v_dot2c_f32_bf16 v147, v41, v41
    v_dot2c_f32_bf16 v144, v42, v180
    v_dot2c_f32_bf16 v146, v42, v42
    v_dot2c_f32_bf16 v145, v43, v180
    v_dot2c_f32_bf16 v147, v43, v43
    v_dot2c_f32_bf16 v144, v44, v180
    v_dot2c_f32_bf16 v146, v44, v44
    v_dot2c_f32_bf16 v145, v45, v180
    v_dot2c_f32_bf16 v147, v45, v45
    v_dot2c_f32_bf16 v144, v46, v180
    v_dot2c_f32_bf16 v146, v46, v46
    v_dot2c_f32_bf16 v145, v47, v180
    v_dot2c_f32_bf16 v147, v47, v47
    s_waitcnt vmcnt(12)
    ds_read_b128 v[64:67], v164 offset:12288
    ds_read_b128 v[68:71], v165 offset:12288
    ds_read_b128 v[72:75], v166 offset:12288
    ds_read_b128 v[76:79], v167 offset:12288
    s_waitcnt lgkmcnt(4)
    v_dot2c_f32_bf16 v144, v48, v180
    v_dot2c_f32_bf16 v146, v48, v48
    v_dot2c_f32_bf16 v145, v49, v180
    v_dot2c_f32_bf16 v147, v49, v49
    v_dot2c_f32_bf16 v144, v50, v180
    v_dot2c_f32_bf16 v146, v50, v50
    v_dot2c_f32_bf16 v145, v51, v180
    v_dot2c_f32_bf16 v147, v51, v51
    v_dot2c_f32_bf16 v144, v52, v180
    v_dot2c_f32_bf16 v146, v52, v52
    v_dot2c_f32_bf16 v145, v53, v180
    v_dot2c_f32_bf16 v147, v53, v53
    v_dot2c_f32_bf16 v144, v54, v180
    v_dot2c_f32_bf16 v146, v54, v54
    v_dot2c_f32_bf16 v145, v55, v180
    v_dot2c_f32_bf16 v147, v55, v55
    v_dot2c_f32_bf16 v144, v56, v180
    v_dot2c_f32_bf16 v146, v56, v56
    v_dot2c_f32_bf16 v145, v57, v180
    v_dot2c_f32_bf16 v147, v57, v57
    v_dot2c_f32_bf16 v144, v58, v180
    v_dot2c_f32_bf16 v146, v58, v58
    v_dot2c_f32_bf16 v145, v59, v180
    v_dot2c_f32_bf16 v147, v59, v59
    v_dot2c_f32_bf16 v144, v60, v180
    v_dot2c_f32_bf16 v146, v60, v60
    v_dot2c_f32_bf16 v145, v61, v180
    v_dot2c_f32_bf16 v147, v61, v61
    v_dot2c_f32_bf16 v144, v62, v180
    v_dot2c_f32_bf16 v146, v62, v62
    v_dot2c_f32_bf16 v145, v63, v180
    v_dot2c_f32_bf16 v147, v63, v63
    s_waitcnt vmcnt(8)
    ds_read_b128 v[80:83], v164 offset:16384
    ds_read_b128 v[84:87], v165 offset:16384
    ds_read_b128 v[88:91], v166 offset:16384
    ds_read_b128 v[92:95], v167 offset:16384
    s_waitcnt lgkmcnt(4)
    v_dot2c_f32_bf16 v144, v64, v180
    v_dot2c_f32_bf16 v146, v64, v64
    v_dot2c_f32_bf16 v145, v65, v180
    v_dot2c_f32_bf16 v147, v65, v65
    v_dot2c_f32_bf16 v144, v66, v180
    v_dot2c_f32_bf16 v146, v66, v66
    v_dot2c_f32_bf16 v145, v67, v180
    v_dot2c_f32_bf16 v147, v67, v67
    v_dot2c_f32_bf16 v144, v68, v180
    v_dot2c_f32_bf16 v146, v68, v68
    v_dot2c_f32_bf16 v145, v69, v180
    v_dot2c_f32_bf16 v147, v69, v69
    v_dot2c_f32_bf16 v144, v70, v180
    v_dot2c_f32_bf16 v146, v70, v70
    v_dot2c_f32_bf16 v145, v71, v180
    v_dot2c_f32_bf16 v147, v71, v71
    v_dot2c_f32_bf16 v144, v72, v180
    v_dot2c_f32_bf16 v146, v72, v72
    v_dot2c_f32_bf16 v145, v73, v180
    v_dot2c_f32_bf16 v147, v73, v73
    v_dot2c_f32_bf16 v144, v74, v180
    v_dot2c_f32_bf16 v146, v74, v74
    v_dot2c_f32_bf16 v145, v75, v180
    v_dot2c_f32_bf16 v147, v75, v75
    v_dot2c_f32_bf16 v144, v76, v180
    v_dot2c_f32_bf16 v146, v76, v76
    v_dot2c_f32_bf16 v145, v77, v180
    v_dot2c_f32_bf16 v147, v77, v77
    v_dot2c_f32_bf16 v144, v78, v180
    v_dot2c_f32_bf16 v146, v78, v78
    v_dot2c_f32_bf16 v145, v79, v180
    v_dot2c_f32_bf16 v147, v79, v79
    s_waitcnt vmcnt(4)
    ds_read_b128 v[96:99], v164 offset:20480
    ds_read_b128 v[100:103], v165 offset:20480
    ds_read_b128 v[104:107], v166 offset:20480
    ds_read_b128 v[108:111], v167 offset:20480
    s_waitcnt lgkmcnt(4)
    v_dot2c_f32_bf16 v144, v80, v180
    v_dot2c_f32_bf16 v146, v80, v80
    v_dot2c_f32_bf16 v145, v81, v180
    v_dot2c_f32_bf16 v147, v81, v81
    v_dot2c_f32_bf16 v144, v82, v180
    v_dot2c_f32_bf16 v146, v82, v82
    v_dot2c_f32_bf16 v145, v83, v180
    v_dot2c_f32_bf16 v147, v83, v83
    v_dot2c_f32_bf16 v144, v84, v180
    v_dot2c_f32_bf16 v146, v84, v84
    v_dot2c_f32_bf16 v145, v85, v180
    v_dot2c_f32_bf16 v147, v85, v85
    v_dot2c_f32_bf16 v144, v86, v180
    v_dot2c_f32_bf16 v146, v86, v86
    v_dot2c_f32_bf16 v145, v87, v180
    v_dot2c_f32_bf16 v147, v87, v87
    v_dot2c_f32_bf16 v144, v88, v180
    v_dot2c_f32_bf16 v146, v88, v88
    v_dot2c_f32_bf16 v145, v89, v180
    v_dot2c_f32_bf16 v147, v89, v89
    v_dot2c_f32_bf16 v144, v90, v180
    v_dot2c_f32_bf16 v146, v90, v90
    v_dot2c_f32_bf16 v145, v91, v180
    v_dot2c_f32_bf16 v147, v91, v91
    v_dot2c_f32_bf16 v144, v92, v180
    v_dot2c_f32_bf16 v146, v92, v92
    v_dot2c_f32_bf16 v145, v93, v180
    v_dot2c_f32_bf16 v147, v93, v93
    v_dot2c_f32_bf16 v144, v94, v180
    v_dot2c_f32_bf16 v146, v94, v94
    v_dot2c_f32_bf16 v145, v95, v180
    v_dot2c_f32_bf16 v147, v95, v95
    s_waitcnt vmcnt(0)
    ds_read_b128 v[112:115], v164 offset:24576
    ds_read_b128 v[116:119], v165 offset:24576
    ds_read_b128 v[120:123], v166 offset:24576
    ds_read_b128 v[124:127], v167 offset:24576
    s_cmp_lg_u32 s44, 1
    s_cbranch_scc1 L_nocnt
    ds_write_b32 v181, v182
L_nocnt:
    s_waitcnt lgkmcnt(4)
    v_dot2c_f32_bf16 v144, v96, v180
    v_dot2c_f32_bf16 v146, v96, v96
    v_dot2c_f32_bf16 v145, v97, v180
    v_dot2c_f32_bf16 v147, v97, v97
    v_dot2c_f32_bf16 v144, v98, v180
    v_dot2c_f32_bf16 v146, v98, v98
    v_dot2c_f32_bf16 v145, v99, v180
    v_dot2c_f32_bf16 v147, v99, v99
    v_dot2c_f32_bf16 v144, v100, v180
    v_dot2c_f32_bf16 v146, v100, v100
    v_dot2c_f32_bf16 v145, v101, v180
    v_dot2c_f32_bf16 v147, v101, v101
    v_dot2c_f32_bf16 v144, v102, v180
    v_dot2c_f32_bf16 v146, v102, v102
    v_dot2c_f32_bf16 v145, v103, v180
    v_dot2c_f32_bf16 v147, v103, v103
    v_dot2c_f32_bf16 v144, v104, v180
    v_dot2c_f32_bf16 v146, v104, v104
    v_dot2c_f32_bf16 v145, v105, v180
    v_dot2c_f32_bf16 v147, v105, v105
    v_dot2c_f32_bf16 v144, v106, v180
    v_dot2c_f32_bf16 v146, v106, v106
    v_dot2c_f32_bf16 v145, v107, v180
    v_dot2c_f32_bf16 v147, v107, v107
    v_dot2c_f32_bf16 v144, v108, v180
    v_dot2c_f32_bf16 v146, v108, v108
    v_dot2c_f32_bf16 v145, v109, v180
    v_dot2c_f32_bf16 v147, v109, v109
    v_dot2c_f32_bf16 v144, v110, v180
    v_dot2c_f32_bf16 v146, v110, v110
    v_dot2c_f32_bf16 v145, v111, v180
    v_dot2c_f32_bf16 v147, v111, v111
    s_waitcnt lgkmcnt(0)
    s_barrier
    v_dot2c_f32_bf16 v144, v112, v180
    v_dot2c_f32_bf16 v146, v112, v112
    v_dot2c_f32_bf16 v145, v113, v180
    v_dot2c_f32_bf16 v147, v113, v113
    v_dot2c_f32_bf16 v144, v114, v180
    v_dot2c_f32_bf16 v146, v114, v114
    v_dot2c_f32_bf16 v145, v115, v180
    v_dot2c_f32_bf16 v147, v115, v115
    v_dot2c_f32_bf16 v144, v116, v180
    v_dot2c_f32_bf16 v146, v116, v116
    v_dot2c_f32_bf16 v145, v117, v180
    v_dot2c_f32_bf16 v147, v117, v117
    v_dot2c_f32_bf16 v144, v118, v180
    v_dot2c_f32_bf16 v146, v118, v118
    v_dot2c_f32_bf16 v145, v119, v180
    v_dot2c_f32_bf16 v147, v119, v119
    v_dot2c_f32_bf16 v144, v120, v180
    v_dot2c_f32_bf16 v146, v120, v120
    v_dot2c_f32_bf16 v145, v121, v180
    v_dot2c_f32_bf16 v147, v121, v121
    v_dot2c_f32_bf16 v144, v122, v180
    v_dot2c_f32_bf16 v146, v122, v122
    v_dot2c_f32_bf16 v145, v123, v180
    v_dot2c_f32_bf16 v147, v123, v123
    v_dot2c_f32_bf16 v144, v124, v180
    v_dot2c_f32_bf16 v146, v124, v124
    v_dot2c_f32_bf16 v145, v125, v180
    v_dot2c_f32_bf16 v147, v125, v125
    v_dot2c_f32_bf16 v144, v126, v180
    v_dot2c_f32_bf16 v146, v126, v126
    v_dot2c_f32_bf16 v145, v127, v180
    v_dot2c_f32_bf16 v147, v127, v127
    s_mov_b32 s51, 0x3b124925
    s_mov_b32 s55, 0x3727c5ac
    s_nop 0
    v_add_f32 v144, v144, v145
    v_add_f32 v146, v146, v147
    v_mov_b32 v145, v144
    v_mov_b32 v147, v146
    s_nop 1
    v_permlane32_swap_b32 v145, v144
    v_permlane32_swap_b32 v147, v146
    s_nop 1
    v_add_f32 v144, v144, v145
    v_add_f32 v146, v146, v147
    v_mul_f32 v144, s51, v144
    v_mul_f32_e64 v146, s51, v146
    v_fma_f32 v146, -v144, v144, v146
    v_max_f32 v146, 0, v146
    v_add_f32 v146, s55, v146
    v_rsq_f32 v148, v146
    s_nop 0
    v_mul_f32 v149, -v144, v148
.p2align 3
    v_lshlrev_b32 v152, 16, v16
    v_and_b32 v153, s61, v16
    v_lshlrev_b32 v154, 16, v17
    v_and_b32 v155, s61, v17
    v_lshlrev_b32 v156, 16, v18
    v_and_b32 v157, s61, v18
    v_lshlrev_b32 v158, 16, v19
    v_and_b32 v159, s61, v19
    v_pk_fma_f32 v[152:153], v[152:153], v[148:149], v[148:149] op_sel:[0,0,1] op_sel_hi:[1,0,1]
    v_pk_fma_f32 v[154:155], v[154:155], v[148:149], v[148:149] op_sel:[0,0,1] op_sel_hi:[1,0,1]
    v_pk_fma_f32 v[156:157], v[156:157], v[148:149], v[148:149] op_sel:[0,0,1] op_sel_hi:[1,0,1]
    v_pk_fma_f32 v[158:159], v[158:159], v[148:149], v[148:149] op_sel:[0,0,1] op_sel_hi:[1,0,1]
    v_cvt_pk_bf16_f32 v16, v152, v153
    v_cvt_pk_bf16_f32 v17, v154, v155
    v_cvt_pk_bf16_f32 v18, v156, v157
    v_cvt_pk_bf16_f32 v19, v158, v159
    v_lshlrev_b32 v152, 16, v20
    v_and_b32 v153, s61, v20
    v_lshlrev_b32 v154, 16, v21
    v_and_b32 v155, s61, v21
    v_lshlrev_b32 v156, 16, v22
    v_and_b32 v157, s61, v22
    v_lshlrev_b32 v158, 16, v23
    v_and_b32 v159, s61, v23
    v_pk_fma_f32 v[152:153], v[152:153], v[148:149], v[148:149] op_sel:[0,0,1] op_sel_hi:[1,0,1]
    v_pk_fma_f32 v[154:155], v[154:155], v[148:149], v[148:149] op_sel:[0,0,1] op_sel_hi:[1,0,1]
    v_pk_fma_f32 v[156:157], v[156:157], v[148:149], v[148:149] op_sel:[0,0,1] op_sel_hi:[1,0,1]
    v_pk_fma_f32 v[158:159], v[158:159], v[148:149], v[148:149] op_sel:[0,0,1] op_sel_hi:[1,0,1]
    v_cvt_pk_bf16_f32 v20, v152, v153
    v_cvt_pk_bf16_f32 v21, v154, v155
    v_cvt_pk_bf16_f32 v22, v156, v157
    v_cvt_pk_bf16_f32 v23, v158, v159
    v_lshlrev_b32 v152, 16, v24
    v_and_b32 v153, s61, v24
    v_lshlrev_b32 v154, 16, v25
    v_and_b32 v155, s61, v25
    v_lshlrev_b32 v156, 16, v26
    v_and_b32 v157, s61, v26
    v_lshlrev_b32 v158, 16, v27
    v_and_b32 v159, s61, v27
    v_pk_fma_f32 v[152:153], v[152:153], v[148:149], v[148:149] op_sel:[0,0,1] op_sel_hi:[1,0,1]
    v_pk_fma_f32 v[154:155], v[154:155], v[148:149], v[148:149] op_sel:[0,0,1] op_sel_hi:[1,0,1]
    v_pk_fma_f32 v[156:157], v[156:157], v[148:149], v[148:149] op_sel:[0,0,1] op_sel_hi:[1,0,1]
    v_pk_fma_f32 v[158:159], v[158:159], v[148:149], v[148:149] op_sel:[0,0,1] op_sel_hi:[1,0,1]
    v_cvt_pk_bf16_f32 v24, v152, v153
    v_cvt_pk_bf16_f32 v25, v154, v155
    v_cvt_pk_bf16_f32 v26, v156, v157
    v_cvt_pk_bf16_f32 v27, v158, v159
    v_lshlrev_b32 v152, 16, v28
    v_and_b32 v153, s61, v28
    v_lshlrev_b32 v154, 16, v29
    v_and_b32 v155, s61, v29
    v_lshlrev_b32 v156, 16, v30
    v_and_b32 v157, s61, v30
    v_lshlrev_b32 v158, 16, v31
    v_and_b32 v159, s61, v31
    v_pk_fma_f32 v[152:153], v[152:153], v[148:149], v[148:149] op_sel:[0,0,1] op_sel_hi:[1,0,1]
    v_pk_fma_f32 v[154:155], v[154:155], v[148:149], v[148:149] op_sel:[0,0,1] op_sel_hi:[1,0,1]
    v_pk_fma_f32 v[156:157], v[156:157], v[148:149], v[148:149] op_sel:[0,0,1] op_sel_hi:[1,0,1]
    v_pk_fma_f32 v[158:159], v[158:159], v[148:149], v[148:149] op_sel:[0,0,1] op_sel_hi:[1,0,1]
    v_cvt_pk_bf16_f32 v28, v152, v153
    v_cvt_pk_bf16_f32 v29, v154, v155
    v_cvt_pk_bf16_f32 v30, v156, v157
    v_cvt_pk_bf16_f32 v31, v158, v159
    v_lshlrev_b32 v152, 16, v32
    v_and_b32 v153, s61, v32
    v_lshlrev_b32 v154, 16, v33
    v_and_b32 v155, s61, v33
    v_lshlrev_b32 v156, 16, v34
    v_and_b32 v157, s61, v34
    v_lshlrev_b32 v158, 16, v35
    v_and_b32 v159, s61, v35
    v_pk_fma_f32 v[152:153], v[152:153], v[148:149], v[148:149] op_sel:[0,0,1] op_sel_hi:[1,0,1]
    v_pk_fma_f32 v[154:155], v[154:155], v[148:149], v[148:149] op_sel:[0,0,1] op_sel_hi:[1,0,1]
    v_pk_fma_f32 v[156:157], v[156:157], v[148:149], v[148:149] op_sel:[0,0,1] op_sel_hi:[1,0,1]
    v_pk_fma_f32 v[158:159], v[158:159], v[148:149], v[148:149] op_sel:[0,0,1] op_sel_hi:[1,0,1]
    v_cvt_pk_bf16_f32 v32, v152, v153
    v_cvt_pk_bf16_f32 v33, v154, v155
    v_cvt_pk_bf16_f32 v34, v156, v157
    v_cvt_pk_bf16_f32 v35, v158, v159
    v_lshlrev_b32 v152, 16, v36
    v_and_b32 v153, s61, v36
    v_lshlrev_b32 v154, 16, v37
    v_and_b32 v155, s61, v37
    v_lshlrev_b32 v156, 16, v38
    v_and_b32 v157, s61, v38
    v_lshlrev_b32 v158, 16, v39
    v_and_b32 v159, s61, v39
    v_pk_fma_f32 v[152:153], v[152:153], v[148:149], v[148:149] op_sel:[0,0,1] op_sel_hi:[1,0,1]
    v_pk_fma_f32 v[154:155], v[154:155], v[148:149], v[148:149] op_sel:[0,0,1] op_sel_hi:[1,0,1]
    v_pk_fma_f32 v[156:157], v[156:157], v[148:149], v[148:149] op_sel:[0,0,1] op_sel_hi:[1,0,1]
    v_pk_fma_f32 v[158:159], v[158:159], v[148:149], v[148:149] op_sel:[0,0,1] op_sel_hi:[1,0,1]
    v_cvt_pk_bf16_f32 v36, v152, v153
    v_cvt_pk_bf16_f32 v37, v154, v155
    v_cvt_pk_bf16_f32 v38, v156, v157
    v_cvt_pk_bf16_f32 v39, v158, v159
    v_lshlrev_b32 v152, 16, v40
    v_and_b32 v153, s61, v40
    v_lshlrev_b32 v154, 16, v41
    v_and_b32 v155, s61, v41
    v_lshlrev_b32 v156, 16, v42
    v_and_b32 v157, s61, v42
    v_lshlrev_b32 v158, 16, v43
    v_and_b32 v159, s61, v43
    v_pk_fma_f32 v[152:153], v[152:153], v[148:149], v[148:149] op_sel:[0,0,1] op_sel_hi:[1,0,1]
    v_pk_fma_f32 v[154:155], v[154:155], v[148:149], v[148:149] op_sel:[0,0,1] op_sel_hi:[1,0,1]
    v_pk_fma_f32 v[156:157], v[156:157], v[148:149], v[148:149] op_sel:[0,0,1] op_sel_hi:[1,0,1]
    v_pk_fma_f32 v[158:159], v[158:159], v[148:149], v[148:149] op_sel:[0,0,1] op_sel_hi:[1,0,1]
    v_cvt_pk_bf16_f32 v40, v152, v153
    v_cvt_pk_bf16_f32 v41, v154, v155
    v_cvt_pk_bf16_f32 v42, v156, v157
    v_cvt_pk_bf16_f32 v43, v158, v159
    v_lshlrev_b32 v152, 16, v44
    v_and_b32 v153, s61, v44
    v_lshlrev_b32 v154, 16, v45
    v_and_b32 v155, s61, v45
    v_lshlrev_b32 v156, 16, v46
    v_and_b32 v157, s61, v46
    v_lshlrev_b32 v158, 16, v47
    v_and_b32 v159, s61, v47
    v_pk_fma_f32 v[152:153], v[152:153], v[148:149], v[148:149] op_sel:[0,0,1] op_sel_hi:[1,0,1]
    v_pk_fma_f32 v[154:155], v[154:155], v[148:149], v[148:149] op_sel:[0,0,1] op_sel_hi:[1,0,1]
    v_pk_fma_f32 v[156:157], v[156:157], v[148:149], v[148:149] op_sel:[0,0,1] op_sel_hi:[1,0,1]
    v_pk_fma_f32 v[158:159], v[158:159], v[148:149], v[148:149] op_sel:[0,0,1] op_sel_hi:[1,0,1]
    v_cvt_pk_bf16_f32 v44, v152, v153
    v_cvt_pk_bf16_f32 v45, v154, v155
    v_cvt_pk_bf16_f32 v46, v156, v157
    v_cvt_pk_bf16_f32 v47, v158, v159
    v_lshlrev_b32 v152, 16, v48
    v_and_b32 v153, s61, v48
    v_lshlrev_b32 v154, 16, v49
    v_and_b32 v155, s61, v49
    v_lshlrev_b32 v156, 16, v50
    v_and_b32 v157, s61, v50
    v_lshlrev_b32 v158, 16, v51
    v_and_b32 v159, s61, v51
    v_pk_fma_f32 v[152:153], v[152:153], v[148:149], v[148:149] op_sel:[0,0,1] op_sel_hi:[1,0,1]
    v_pk_fma_f32 v[154:155], v[154:155], v[148:149], v[148:149] op_sel:[0,0,1] op_sel_hi:[1,0,1]
    v_pk_fma_f32 v[156:157], v[156:157], v[148:149], v[148:149] op_sel:[0,0,1] op_sel_hi:[1,0,1]
    v_pk_fma_f32 v[158:159], v[158:159], v[148:149], v[148:149] op_sel:[0,0,1] op_sel_hi:[1,0,1]
    v_cvt_pk_bf16_f32 v48, v152, v153
    v_cvt_pk_bf16_f32 v49, v154, v155
    v_cvt_pk_bf16_f32 v50, v156, v157
    v_cvt_pk_bf16_f32 v51, v158, v159
    v_lshlrev_b32 v152, 16, v52
    v_and_b32 v153, s61, v52
    v_lshlrev_b32 v154, 16, v53
    v_and_b32 v155, s61, v53
    v_lshlrev_b32 v156, 16, v54
    v_and_b32 v157, s61, v54
    v_lshlrev_b32 v158, 16, v55
    v_and_b32 v159, s61, v55
    v_pk_fma_f32 v[152:153], v[152:153], v[148:149], v[148:149] op_sel:[0,0,1] op_sel_hi:[1,0,1]
    v_pk_fma_f32 v[154:155], v[154:155], v[148:149], v[148:149] op_sel:[0,0,1] op_sel_hi:[1,0,1]
    v_pk_fma_f32 v[156:157], v[156:157], v[148:149], v[148:149] op_sel:[0,0,1] op_sel_hi:[1,0,1]
    v_pk_fma_f32 v[158:159], v[158:159], v[148:149], v[148:149] op_sel:[0,0,1] op_sel_hi:[1,0,1]
    v_cvt_pk_bf16_f32 v52, v152, v153
    v_cvt_pk_bf16_f32 v53, v154, v155
    v_cvt_pk_bf16_f32 v54, v156, v157
    v_cvt_pk_bf16_f32 v55, v158, v159
    v_lshlrev_b32 v152, 16, v56
    v_and_b32 v153, s61, v56
    v_lshlrev_b32 v154, 16, v57
    v_and_b32 v155, s61, v57
    v_lshlrev_b32 v156, 16, v58
    v_and_b32 v157, s61, v58
    v_lshlrev_b32 v158, 16, v59
    v_and_b32 v159, s61, v59
    v_pk_fma_f32 v[152:153], v[152:153], v[148:149], v[148:149] op_sel:[0,0,1] op_sel_hi:[1,0,1]
    v_pk_fma_f32 v[154:155], v[154:155], v[148:149], v[148:149] op_sel:[0,0,1] op_sel_hi:[1,0,1]
    v_pk_fma_f32 v[156:157], v[156:157], v[148:149], v[148:149] op_sel:[0,0,1] op_sel_hi:[1,0,1]
    v_pk_fma_f32 v[158:159], v[158:159], v[148:149], v[148:149] op_sel:[0,0,1] op_sel_hi:[1,0,1]
    v_cvt_pk_bf16_f32 v56, v152, v153
    v_cvt_pk_bf16_f32 v57, v154, v155
    v_cvt_pk_bf16_f32 v58, v156, v157
    v_cvt_pk_bf16_f32 v59, v158, v159
    v_lshlrev_b32 v152, 16, v60
    v_and_b32 v153, s61, v60
    v_lshlrev_b32 v154, 16, v61
    v_and_b32 v155, s61, v61
    v_lshlrev_b32 v156, 16, v62
    v_and_b32 v157, s61, v62
    v_lshlrev_b32 v158, 16, v63
    v_and_b32 v159, s61, v63
    v_pk_fma_f32 v[152:153], v[152:153], v[148:149], v[148:149] op_sel:[0,0,1] op_sel_hi:[1,0,1]
    v_pk_fma_f32 v[154:155], v[154:155], v[148:149], v[148:149] op_sel:[0,0,1] op_sel_hi:[1,0,1]
    v_pk_fma_f32 v[156:157], v[156:157], v[148:149], v[148:149] op_sel:[0,0,1] op_sel_hi:[1,0,1]
    v_pk_fma_f32 v[158:159], v[158:159], v[148:149], v[148:149] op_sel:[0,0,1] op_sel_hi:[1,0,1]
    v_cvt_pk_bf16_f32 v60, v152, v153
    v_cvt_pk_bf16_f32 v61, v154, v155
    v_cvt_pk_bf16_f32 v62, v156, v157
    v_cvt_pk_bf16_f32 v63, v158, v159
    v_lshlrev_b32 v152, 16, v64
    v_and_b32 v153, s61, v64
    v_lshlrev_b32 v154, 16, v65
    v_and_b32 v155, s61, v65
    v_lshlrev_b32 v156, 16, v66
    v_and_b32 v157, s61, v66
    v_lshlrev_b32 v158, 16, v67
    v_and_b32 v159, s61, v67
    v_pk_fma_f32 v[152:153], v[152:153], v[148:149], v[148:149] op_sel:[0,0,1] op_sel_hi:[1,0,1]
    v_pk_fma_f32 v[154:155], v[154:155], v[148:149], v[148:149] op_sel:[0,0,1] op_sel_hi:[1,0,1]
    v_pk_fma_f32 v[156:157], v[156:157], v[148:149], v[148:149] op_sel:[0,0,1] op_sel_hi:[1,0,1]
    v_pk_fma_f32 v[158:159], v[158:159], v[148:149], v[148:149] op_sel:[0,0,1] op_sel_hi:[1,0,1]
    v_cvt_pk_bf16_f32 v64, v152, v153
    v_cvt_pk_bf16_f32 v65, v154, v155
    v_cvt_pk_bf16_f32 v66, v156, v157
    v_cvt_pk_bf16_f32 v67, v158, v159
    v_lshlrev_b32 v152, 16, v68
    v_and_b32 v153, s61, v68
    v_lshlrev_b32 v154, 16, v69
    v_and_b32 v155, s61, v69
    v_lshlrev_b32 v156, 16, v70
    v_and_b32 v157, s61, v70
    v_lshlrev_b32 v158, 16, v71
    v_and_b32 v159, s61, v71
    v_pk_fma_f32 v[152:153], v[152:153], v[148:149], v[148:149] op_sel:[0,0,1] op_sel_hi:[1,0,1]
    v_pk_fma_f32 v[154:155], v[154:155], v[148:149], v[148:149] op_sel:[0,0,1] op_sel_hi:[1,0,1]
    v_pk_fma_f32 v[156:157], v[156:157], v[148:149], v[148:149] op_sel:[0,0,1] op_sel_hi:[1,0,1]
    v_pk_fma_f32 v[158:159], v[158:159], v[148:149], v[148:149] op_sel:[0,0,1] op_sel_hi:[1,0,1]
    v_cvt_pk_bf16_f32 v68, v152, v153
    v_cvt_pk_bf16_f32 v69, v154, v155
    v_cvt_pk_bf16_f32 v70, v156, v157
    v_cvt_pk_bf16_f32 v71, v158, v159
    ds_read_b32 v5, v3 offset:28
    v_lshlrev_b32 v152, 16, v72
    v_and_b32 v153, s61, v72
    v_lshlrev_b32 v154, 16, v73
    v_and_b32 v155, s61, v73
    v_lshlrev_b32 v156, 16, v74
    v_and_b32 v157, s61, v74
    v_lshlrev_b32 v158, 16, v75
    v_and_b32 v159, s61, v75
    v_pk_fma_f32 v[152:153], v[152:153], v[148:149], v[148:149] op_sel:[0,0,1] op_sel_hi:[1,0,1]
    v_pk_fma_f32 v[154:155], v[154:155], v[148:149], v[148:149] op_sel:[0,0,1] op_sel_hi:[1,0,1]
    v_pk_fma_f32 v[156:157], v[156:157], v[148:149], v[148:149] op_sel:[0,0,1] op_sel_hi:[1,0,1]
    v_pk_fma_f32 v[158:159], v[158:159], v[148:149], v[148:149] op_sel:[0,0,1] op_sel_hi:[1,0,1]
    v_cvt_pk_bf16_f32 v72, v152, v153
    v_cvt_pk_bf16_f32 v73, v154, v155
    v_cvt_pk_bf16_f32 v74, v156, v157
    v_cvt_pk_bf16_f32 v75, v158, v159
    s_waitcnt lgkmcnt(0)
    v_cmp_gt_u32 vcc, 4, v5
    s_cmp_ge_u32 s60, 11
    s_nop 2
    s_cbranch_vccnz L_gq0
L_gq0_x:
    s_nop 0
    ds_read_b64_tr_b16 v[240:241], v168 offset:0
    ds_read_b64_tr_b16 v[242:243], v168 offset:768
    ds_read_b64_tr_b16 v[244:245], v168 offset:56
    ds_read_b64_tr_b16 v[246:247], v168 offset:824
    ds_read_b64_tr_b16 v[248:249], v168 offset:112
    ds_read_b64_tr_b16 v[250:251], v168 offset:880
    ds_read_b64_tr_b16 v[252:253], v168 offset:3072
    ds_read_b64_tr_b16 v[254:255], v168 offset:3840
    ds_read_b64_tr_b16 v[8:9], v168 offset:3128
    ds_read_b64_tr_b16 v[10:11], v168 offset:3896
    ds_read_b64_tr_b16 v[12:13], v168 offset:3184
    ds_read_b64_tr_b16 v[14:15], v168 offset:3952
    ds_read_b64_tr_b16 v[128:129], v168 offset:6144
    ds_read_b64_tr_b16 v[130:131], v168 offset:6912
    v_lshlrev_b32 v152, 16, v76
    v_and_b32 v153, s61, v76
    v_lshlrev_b32 v154, 16, v77
    v_and_b32 v155, s61, v77
    v_lshlrev_b32 v156, 16, v78
    v_and_b32 v157, s61, v78
    v_lshlrev_b32 v158, 16, v79
    v_and_b32 v159, s61, v79
    v_pk_fma_f32 v[152:153], v[152:153], v[148:149], v[148:149] op_sel:[0,0,1] op_sel_hi:[1,0,1]
    v_pk_fma_f32 v[154:155], v[154:155], v[148:149], v[148:149] op_sel:[0,0,1] op_sel_hi:[1,0,1]
    v_pk_fma_f32 v[156:157], v[156:157], v[148:149], v[148:149] op_sel:[0,0,1] op_sel_hi:[1,0,1]
    v_pk_fma_f32 v[158:159], v[158:159], v[148:149], v[148:149] op_sel:[0,0,1] op_sel_hi:[1,0,1]
    v_cvt_pk_bf16_f32 v76, v152, v153
    v_cvt_pk_bf16_f32 v77, v154, v155
    v_cvt_pk_bf16_f32 v78, v156, v157
    v_cvt_pk_bf16_f32 v79, v158, v159
    v_lshlrev_b32 v152, 16, v80
    v_and_b32 v153, s61, v80
    v_lshlrev_b32 v154, 16, v81
    v_and_b32 v155, s61, v81
    v_lshlrev_b32 v156, 16, v82
    v_and_b32 v157, s61, v82
    v_lshlrev_b32 v158, 16, v83
    v_and_b32 v159, s61, v83
    v_pk_fma_f32 v[152:153], v[152:153], v[148:149], v[148:149] op_sel:[0,0,1] op_sel_hi:[1,0,1]
    v_pk_fma_f32 v[154:155], v[154:155], v[148:149], v[148:149] op_sel:[0,0,1] op_sel_hi:[1,0,1]
    v_pk_fma_f32 v[156:157], v[156:157], v[148:149], v[148:149] op_sel:[0,0,1] op_sel_hi:[1,0,1]
    v_pk_fma_f32 v[158:159], v[158:159], v[148:149], v[148:149] op_sel:[0,0,1] op_sel_hi:[1,0,1]
    v_cvt_pk_bf16_f32 v80, v152, v153
    v_cvt_pk_bf16_f32 v81, v154, v155
    v_cvt_pk_bf16_f32 v82, v156, v157
    v_cvt_pk_bf16_f32 v83, v158, v159
    s_cbranch_scc1 L_pav
    s_waitcnt lgkmcnt(8)
    v_mfma_f32_32x32x16_bf16 v[192:207], v[240:243], v[16:19], 0
    ds_read_b64_tr_b16 v[132:133], v168 offset:6200
    ds_read_b64_tr_b16 v[134:135], v168 offset:6968
    ds_read_b64_tr_b16 v[136:137], v168 offset:6256
    ds_read_b64_tr_b16 v[138:139], v168 offset:7024
    v_lshlrev_b32 v152, 16, v84
    v_and_b32 v153, s61, v84
    v_lshlrev_b32 v154, 16, v85
    v_and_b32 v155, s61, v85
    v_mfma_f32_32x32x16_bf16 v[208:223], v[244:247], v[16:19], 0
    ds_read_b64_tr_b16 v[140:141], v168 offset:9216
    ds_read_b64_tr_b16 v[142:143], v168 offset:9984
    v_lshlrev_b32 v156, 16, v86
    v_and_b32 v157, s61, v86
    v_lshlrev_b32 v158, 16, v87
    v_and_b32 v159, s61, v87
    v_mfma_f32_32x32x16_bf16 v[224:239], v[248:251], v[16:19], 0
    ds_read_b64_tr_b16 v[240:241], v168 offset:9272
    ds_read_b64_tr_b16 v[242:243], v168 offset:10040
    v_fma_f32 v152, v152, v148, v149
    v_fma_f32 v153, v153, v148, v149
    v_fma_f32 v154, v154, v148, v149
    v_fma_f32 v155, v155, v148, v149
    s_waitcnt lgkmcnt(10)
    s_nop 0
    v_mfma_f32_32x32x16_bf16 v[192:207], v[252:255], v[20:23], v[192:207]
    ds_read_b64_tr_b16 v[244:245], v168 offset:9328
    ds_read_b64_tr_b16 v[246:247], v168 offset:10096
    v_fma_f32 v156, v156, v148, v149
    v_fma_f32 v157, v157, v148, v149
    v_fma_f32 v158, v158, v148, v149
    v_fma_f32 v159, v159, v148, v149
    v_mfma_f32_32x32x16_bf16 v[208:223], v[8:11], v[20:23], v[208:223]
    ds_read_b64_tr_b16 v[248:249], v168 offset:12288
    ds_read_b64_tr_b16 v[250:251], v168 offset:13056
    v_cvt_pk_bf16_f32 v84, v152, v153
    v_cvt_pk_bf16_f32 v85, v154, v155
    v_cvt_pk_bf16_f32 v86, v156, v157
    v_mfma_f32_32x32x16_bf16 v[224:239], v[12:15], v[20:23], v[224:239]
    ds_read_b64_tr_b16 v[252:253], v168 offset:12344
    ds_read_b64_tr_b16 v[254:255], v168 offset:13112
    v_cvt_pk_bf16_f32 v87, v158, v159
    v_lshlrev_b32_e64 v152, 16, v88
    v_and_b32 v153, s61, v88
    s_waitcnt lgkmcnt(10)
    v_mfma_f32_32x32x16_bf16 v[192:207], v[128:131], v[24:27], v[192:207]
    ds_read_b64_tr_b16 v[8:9], v168 offset:12400
    ds_read_b64_tr_b16 v[10:11], v168 offset:13168
    v_lshlrev_b32 v154, 16, v89
    v_and_b32 v155, s61, v89
    v_lshlrev_b32_e64 v156, 16, v90
    v_mfma_f32_32x32x16_bf16 v[208:223], v[132:135], v[24:27], v[208:223]
    ds_read_b64_tr_b16 v[12:13], v168 offset:15360
    ds_read_b64_tr_b16 v[14:15], v168 offset:16128
    v_and_b32 v157, s61, v90
    v_lshlrev_b32 v158, 16, v91
    v_and_b32_e64 v159, s61, v91
    v_mfma_f32_32x32x16_bf16 v[224:239], v[136:139], v[24:27], v[224:239]
    ds_read_b64_tr_b16 v[128:129], v168 offset:15416
    ds_read_b64_tr_b16 v[130:131], v168 offset:16184
    v_fma_f32 v152, v152, v148, v149
    v_fma_f32 v153, v153, v148, v149
    v_fma_f32 v154, v154, v148, v149
    s_waitcnt lgkmcnt(10)
    s_nop 0
    v_mfma_f32_32x32x16_bf16 v[192:207], v[140:143], v[28:31], v[192:207]
    ds_read_b64_tr_b16 v[132:133], v168 offset:15472
    ds_read_b64_tr_b16 v[134:135], v168 offset:16240
    v_fma_f32 v155, v155, v148, v149
    v_fma_f32 v156, v156, v148, v149
    v_fma_f32 v157, v157, v148, v149
    v_mfma_f32_32x32x16_bf16 v[208:223], v[240:243], v[28:31], v[208:223]
    ds_read_b64_tr_b16 v[136:137], v168 offset:18432
    ds_read_b64_tr_b16 v[138:139], v168 offset:19200
    v_fma_f32 v158, v158, v148, v149
    v_fma_f32 v159, v159, v148, v149
    v_cvt_pk_bf16_f32 v88, v152, v153
    v_mfma_f32_32x32x16_bf16 v[224:239], v[244:247], v[28:31], v[224:239]
    ds_read_b64_tr_b16 v[140:141], v168 offset:18488
    ds_read_b64_tr_b16 v[142:143], v168 offset:19256
    v_cvt_pk_bf16_f32 v89, v154, v155
    v_cvt_pk_bf16_f32 v90, v156, v157
    v_cvt_pk_bf16_f32 v91, v158, v159
    s_waitcnt lgkmcnt(10)
    v_mfma_f32_32x32x16_bf16 v[192:207], v[248:251], v[32:35], v[192:207]
    ds_read_b64_tr_b16 v[240:241], v168 offset:18544
    ds_read_b64_tr_b16 v[242:243], v168 offset:19312
    v_lshlrev_b32 v152, 16, v92
    v_and_b32 v153, s61, v92
    v_lshlrev_b32 v154, 16, v93
    v_mfma_f32_32x32x16_bf16 v[208:223], v[252:255], v[32:35], v[208:223]
    ds_read_b64_tr_b16 v[244:245], v168 offset:21504
    ds_read_b64_tr_b16 v[246:247], v168 offset:22272
    v_and_b32 v155, s61, v93
    v_lshlrev_b32 v156, 16, v94
    v_and_b32_e64 v157, s61, v94
    v_mfma_f32_32x32x16_bf16 v[224:239], v[8:11], v[32:35], v[224:239]
    ds_read_b32 v5, v3 offset:56
    ds_read_b64_tr_b16 v[248:249], v168 offset:21560
    ds_read_b64_tr_b16 v[250:251], v168 offset:22328
    v_lshlrev_b32 v158, 16, v95
    v_and_b32 v159, s61, v95
    v_fma_f32 v152, v152, v148, v149
    s_waitcnt lgkmcnt(11)
    s_nop 0
    v_mfma_f32_32x32x16_bf16 v[192:207], v[12:15], v[36:39], v[192:207]
    ds_read_b64_tr_b16 v[252:253], v168 offset:21616
    ds_read_b64_tr_b16 v[254:255], v168 offset:22384
    v_fma_f32 v153, v153, v148, v149
    v_fma_f32 v154, v154, v148, v149
    v_fma_f32 v155, v155, v148, v149
    v_mfma_f32_32x32x16_bf16 v[208:223], v[128:131], v[36:39], v[208:223]
    s_waitcnt lgkmcnt(4)
    v_cmp_gt_u32 vcc, 4, v5
    v_fma_f32 v156, v156, v148, v149
    v_fma_f32 v157, v157, v148, v149
    v_fma_f32 v158, v158, v148, v149
    v_mfma_f32_32x32x16_bf16 v[224:239], v[132:135], v[36:39], v[224:239]
    s_cbranch_vccnz L_gq24
L_gq24_x:
    s_nop 0
    ds_read_b64_tr_b16 v[8:9], v168 offset:24576
    ds_read_b64_tr_b16 v[10:11], v168 offset:25344
    ds_read_b64_tr_b16 v[12:13], v168 offset:24632
    ds_read_b64_tr_b16 v[14:15], v168 offset:25400
    v_fma_f32 v159, v159, v148, v149
    v_cvt_pk_bf16_f32 v92, v152, v153
    v_cvt_pk_bf16_f32 v93, v154, v155
    v_mfma_f32_32x32x16_bf16 v[192:207], v[136:139], v[40:43], v[192:207]
    ds_read_b64_tr_b16 v[128:129], v168 offset:24688
    ds_read_b64_tr_b16 v[130:131], v168 offset:25456
    v_cvt_pk_bf16_f32 v94, v156, v157
    v_cvt_pk_bf16_f32 v95, v158, v159
    v_lshlrev_b32_e64 v152, 16, v96
    v_mfma_f32_32x32x16_bf16 v[208:223], v[140:143], v[40:43], v[208:223]
    ds_read_b64_tr_b16 v[132:133], v168 offset:27648
    ds_read_b64_tr_b16 v[134:135], v168 offset:28416
    v_and_b32 v153, s61, v96
    v_lshlrev_b32 v154, 16, v97
    v_and_b32_e64 v155, s61, v97
    v_mfma_f32_32x32x16_bf16 v[224:239], v[240:243], v[40:43], v[224:239]
    ds_read_b64_tr_b16 v[136:137], v168 offset:27704
    ds_read_b64_tr_b16 v[138:139], v168 offset:28472
    v_lshlrev_b32 v156, 16, v98
    v_and_b32 v157, s61, v98
    v_lshlrev_b32 v158, 16, v99
    s_waitcnt lgkmcnt(10)
    v_mfma_f32_32x32x16_bf16 v[192:207], v[244:247], v[44:47], v[192:207]
    ds_read_b64_tr_b16 v[140:141], v168 offset:27760
    ds_read_b64_tr_b16 v[142:143], v168 offset:28528
    v_and_b32_e64 v159, s61, v99
    v_fma_f32 v152, v152, v148, v149
    v_fma_f32 v153, v153, v148, v149
    v_mfma_f32_32x32x16_bf16 v[208:223], v[248:251], v[44:47], v[208:223]
    ds_read_b64_tr_b16 v[240:241], v168 offset:30720
    ds_read_b64_tr_b16 v[242:243], v168 offset:31488
    v_fma_f32 v154, v154, v148, v149
    v_fma_f32 v155, v155, v148, v149
    v_fma_f32 v156, v156, v148, v149
    v_mfma_f32_32x32x16_bf16 v[224:239], v[252:255], v[44:47], v[224:239]
    ds_read_b64_tr_b16 v[244:245], v168 offset:30776
    ds_read_b64_tr_b16 v[246:247], v168 offset:31544
    v_fma_f32 v157, v157, v148, v149
    v_fma_f32 v158, v158, v148, v149
    v_fma_f32 v159, v159, v148, v149
    s_waitcnt lgkmcnt(10)
    s_nop 0
    v_mfma_f32_32x32x16_bf16 v[192:207], v[8:11], v[48:51], v[192:207]
    ds_read_b64_tr_b16 v[248:249], v168 offset:30832
    ds_read_b64_tr_b16 v[250:251], v168 offset:31600
    v_cvt_pk_bf16_f32 v96, v152, v153
    v_cvt_pk_bf16_f32 v97, v154, v155
    v_cvt_pk_bf16_f32 v98, v156, v157
    v_mfma_f32_32x32x16_bf16 v[208:223], v[12:15], v[48:51], v[208:223]
    ds_read_b64_tr_b16 v[252:253], v168 offset:33792
    ds_read_b64_tr_b16 v[254:255], v168 offset:34560
    v_cvt_pk_bf16_f32 v99, v158, v159
    v_lshlrev_b32 v152, 16, v100
    v_and_b32 v153, s61, v100
    v_mfma_f32_32x32x16_bf16 v[224:239], v[128:131], v[48:51], v[224:239]
    ds_read_b64_tr_b16 v[8:9], v168 offset:33848
    ds_read_b64_tr_b16 v[10:11], v168 offset:34616
    v_lshlrev_b32 v154, 16, v101
    v_and_b32 v155, s61, v101
    v_lshlrev_b32 v156, 16, v102
    s_waitcnt lgkmcnt(10)
    v_mfma_f32_32x32x16_bf16 v[192:207], v[132:135], v[52:55], v[192:207]
    ds_read_b64_tr_b16 v[12:13], v168 offset:33904
    ds_read_b64_tr_b16 v[14:15], v168 offset:34672
    v_and_b32 v157, s61, v102
    v_lshlrev_b32 v158, 16, v103
    v_and_b32_e64 v159, s61, v103
    v_mfma_f32_32x32x16_bf16 v[208:223], v[136:139], v[52:55], v[208:223]
    ds_read_b64_tr_b16 v[128:129], v168 offset:36864
    ds_read_b64_tr_b16 v[130:131], v168 offset:37632
    v_fma_f32 v152, v152, v148, v149
    v_fma_f32 v153, v153, v148, v149
    v_fma_f32 v154, v154, v148, v149
    v_mfma_f32_32x32x16_bf16 v[224:239], v[140:143], v[52:55], v[224:239]
    ds_read_b64_tr_b16 v[132:133], v168 offset:36920
    ds_read_b64_tr_b16 v[134:135], v168 offset:37688
    v_fma_f32 v155, v155, v148, v149
    v_fma_f32 v156, v156, v148, v149
    v_fma_f32 v157, v157, v148, v149
    s_waitcnt lgkmcnt(10)
    s_nop 0
    v_mfma_f32_32x32x16_bf16 v[192:207], v[240:243], v[56:59], v[192:207]
    ds_read_b64_tr_b16 v[136:137], v168 offset:36976
    ds_read_b64_tr_b16 v[138:139], v168 offset:37744
    v_fma_f32 v158, v158, v148, v149
    v_fma_f32 v159, v159, v148, v149
    v_cvt_pk_bf16_f32 v100, v152, v153
    v_mfma_f32_32x32x16_bf16 v[208:223], v[244:247], v[56:59], v[208:223]
    ds_read_b64_tr_b16 v[140:141], v168 offset:39936
    ds_read_b64_tr_b16 v[142:143], v168 offset:40704
    v_cvt_pk_bf16_f32 v101, v154, v155
    v_cvt_pk_bf16_f32 v102, v156, v157
    v_cvt_pk_bf16_f32 v103, v158, v159
    v_mfma_f32_32x32x16_bf16 v[224:239], v[248:251], v[56:59], v[224:239]
    ds_read_b64_tr_b16 v[240:241], v168 offset:39992
    ds_read_b64_tr_b16 v[242:243], v168 offset:40760
    v_lshlrev_b32 v152, 16, v104
    v_and_b32 v153, s61, v104
    v_lshlrev_b32 v154, 16, v105
    s_waitcnt lgkmcnt(10)
    v_mfma_f32_32x32x16_bf16 v[192:207], v[252:255], v[60:63], v[192:207]
    s_mov_b64 exec, 1
    ds_add_u32 v3, v4 offset:88
    s_mov_b64 exec, -1
    ds_read_b64_tr_b16 v[244:245], v168 offset:40048
    ds_read_b64_tr_b16 v[246:247], v168 offset:40816
    v_and_b32 v155, s61, v105
    v_lshlrev_b32 v156, 16, v106
    v_and_b32_e64 v157, s61, v106
    v_mfma_f32_32x32x16_bf16 v[208:223], v[8:11], v[60:63], v[208:223]
    ds_read_b64_tr_b16 v[248:249], v168 offset:43008
    ds_read_b64_tr_b16 v[250:251], v168 offset:43776
    v_lshlrev_b32 v158, 16, v107
    v_and_b32 v159, s61, v107
    v_fma_f32 v152, v152, v148, v149
    v_mfma_f32_32x32x16_bf16 v[224:239], v[12:15], v[60:63], v[224:239]
    ds_read_b64_tr_b16 v[252:253], v168 offset:43064
    ds_read_b64_tr_b16 v[254:255], v168 offset:43832
    v_fma_f32 v153, v153, v148, v149
    v_fma_f32 v154, v154, v148, v149
    v_fma_f32 v155, v155, v148, v149
    s_waitcnt lgkmcnt(11)
    s_nop 0
    v_mfma_f32_32x32x16_bf16 v[192:207], v[128:131], v[64:67], v[192:207]
    ds_read_b64_tr_b16 v[8:9], v168 offset:43120
    ds_read_b64_tr_b16 v[10:11], v168 offset:43888
    v_fma_f32 v156, v156, v148, v149
    v_fma_f32 v157, v157, v148, v149
    v_fma_f32 v158, v158, v148, v149
    v_mfma_f32_32x32x16_bf16 v[208:223], v[132:135], v[64:67], v[208:223]
    ds_read_b64_tr_b16 v[12:13], v168 offset:46080
    ds_read_b64_tr_b16 v[14:15], v168 offset:46848
    v_fma_f32 v159, v159, v148, v149
    v_cvt_pk_bf16_f32 v104, v152, v153
    v_cvt_pk_bf16_f32 v105, v154, v155
    v_mfma_f32_32x32x16_bf16 v[224:239], v[136:139], v[64:67], v[224:239]
    ds_read_b32 v5, v3 offset:60
    ds_read_b64_tr_b16 v[128:129], v168 offset:46136
    ds_read_b64_tr_b16 v[130:131], v168 offset:46904
    v_cvt_pk_bf16_f32 v106, v156, v157
    v_cvt_pk_bf16_f32 v107, v158, v159
    v_lshlrev_b32 v152, 16, v108
    s_waitcnt lgkmcnt(11)
    v_mfma_f32_32x32x16_bf16 v[192:207], v[140:143], v[68:71], v[192:207]
    ds_read_b64_tr_b16 v[132:133], v168 offset:46192
    ds_read_b64_tr_b16 v[134:135], v168 offset:46960
    v_and_b32 v153, s61, v108
    v_lshlrev_b32 v154, 16, v109
    v_and_b32_e64 v155, s61, v109
    v_mfma_f32_32x32x16_bf16 v[208:223], v[240:243], v[68:71], v[208:223]
    s_waitcnt lgkmcnt(4)
    v_cmp_gt_u32 vcc, 4, v5
    v_lshlrev_b32 v156, 16, v110
    v_and_b32 v157, s61, v110
    v_lshlrev_b32_e64 v158, 16, v111
    v_mfma_f32_32x32x16_bf16 v[224:239], v[244:247], v[68:71], v[224:239]
    s_cbranch_vccnz L_gq48
L_gq48_x:
    ds_read_b64_tr_b16 v[136:137], v169 offset:0
    ds_read_b64_tr_b16 v[138:139], v169 offset:768
    ds_read_b64_tr_b16 v[140:141], v169 offset:56
    ds_read_b64_tr_b16 v[142:143], v169 offset:824
    v_and_b32 v159, s61, v111
    v_fma_f32 v152, v152, v148, v149
    v_fma_f32 v153, v153, v148, v149
    v_mfma_f32_32x32x16_bf16 v[192:207], v[248:251], v[72:75], v[192:207]
    ds_read_b64_tr_b16 v[240:241], v169 offset:112
    ds_read_b64_tr_b16 v[242:243], v169 offset:880
    v_fma_f32 v154, v154, v148, v149
    v_fma_f32 v155, v155, v148, v149
    v_fma_f32 v156, v156, v148, v149
    v_mfma_f32_32x32x16_bf16 v[208:223], v[252:255], v[72:75], v[208:223]
    ds_read_b64_tr_b16 v[244:245], v169 offset:28672
    ds_read_b64_tr_b16 v[246:247], v169 offset:29440
    v_fma_f32 v157, v157, v148, v149
    v_fma_f32 v158, v158, v148, v149
    v_fma_f32 v159, v159, v148, v149
    v_mfma_f32_32x32x16_bf16 v[224:239], v[8:11], v[72:75], v[224:239]
    ds_read_b64_tr_b16 v[248:249], v169 offset:28728
    ds_read_b64_tr_b16 v[250:251], v169 offset:29496
    v_cvt_pk_bf16_f32 v108, v152, v153
    v_cvt_pk_bf16_f32 v109, v154, v155
    v_cvt_pk_bf16_f32 v110, v156, v157
    s_waitcnt lgkmcnt(10)
    v_mfma_f32_32x32x16_bf16 v[192:207], v[12:15], v[76:79], v[192:207]
    ds_read_b64_tr_b16 v[252:253], v169 offset:28784
    ds_read_b64_tr_b16 v[254:255], v169 offset:29552
    v_cvt_pk_bf16_f32 v111, v158, v159
    v_lshlrev_b32 v152, 16, v112
    v_and_b32_e64 v153, s61, v112
    v_mfma_f32_32x32x16_bf16 v[208:223], v[128:131], v[76:79], v[208:223]
    ds_read_b64_tr_b16 v[8:9], v170 offset:0
    ds_read_b64_tr_b16 v[10:11], v170 offset:768
    v_lshlrev_b32 v154, 16, v113
    v_and_b32 v155, s61, v113
    v_lshlrev_b32_e64 v156, 16, v114
    v_mfma_f32_32x32x16_bf16 v[224:239], v[132:135], v[76:79], v[224:239]
    ds_read_b64_tr_b16 v[12:13], v170 offset:56
    ds_read_b64_tr_b16 v[14:15], v170 offset:824
    v_and_b32 v157, s61, v114
    v_lshlrev_b32 v158, 16, v115
    v_and_b32 v159, s61, v115
    s_waitcnt lgkmcnt(10)
    v_mfma_f32_32x32x16_bf16 v[192:207], v[136:139], v[80:83], v[192:207]
    ds_read_b64_tr_b16 v[128:129], v170 offset:112
    ds_read_b64_tr_b16 v[130:131], v170 offset:880
    v_fma_f32 v152, v152, v148, v149
    v_fma_f32 v153, v153, v148, v149
    v_fma_f32 v154, v154, v148, v149
    v_mfma_f32_32x32x16_bf16 v[208:223], v[140:143], v[80:83], v[208:223]
    ds_read_b64_tr_b16 v[132:133], v170 offset:28672
    ds_read_b64_tr_b16 v[134:135], v170 offset:29440
    v_fma_f32 v155, v155, v148, v149
    v_fma_f32 v156, v156, v148, v149
    v_fma_f32 v157, v157, v148, v149
    v_mfma_f32_32x32x16_bf16 v[224:239], v[240:243], v[80:83], v[224:239]
    ds_read_b32 v5, v3 offset:104
    ds_read_b64_tr_b16 v[136:137], v170 offset:28728
    ds_read_b64_tr_b16 v[138:139], v170 offset:29496
    v_fma_f32 v158, v158, v148, v149
    v_fma_f32 v159, v159, v148, v149
    v_cvt_pk_bf16_f32 v112, v152, v153
    s_waitcnt lgkmcnt(11)
    s_nop 0
    v_mfma_f32_32x32x16_bf16 v[192:207], v[244:247], v[84:87], v[192:207]
    ds_read_b64_tr_b16 v[140:141], v170 offset:28784
    ds_read_b64_tr_b16 v[142:143], v170 offset:29552
    v_cvt_pk_bf16_f32 v113, v154, v155
    v_cvt_pk_bf16_f32 v114, v156, v157
    v_cvt_pk_bf16_f32 v115, v158, v159
    v_mfma_f32_32x32x16_bf16 v[208:223], v[248:251], v[84:87], v[208:223]
    s_waitcnt lgkmcnt(4)
    v_cmp_gt_u32 vcc, 4, v5
    v_lshlrev_b32 v152, 16, v116
    v_and_b32 v153, s61, v116
    v_lshlrev_b32_e64 v154, 16, v117
    v_mfma_f32_32x32x16_bf16 v[224:239], v[252:255], v[84:87], v[224:239]
    s_cbranch_vccnz L_gq60
L_gq60_x:
    ds_read_b64_tr_b16 v[240:241], v169 offset:7168
    ds_read_b64_tr_b16 v[242:243], v169 offset:7936
    ds_read_b64_tr_b16 v[244:245], v169 offset:7224
    ds_read_b64_tr_b16 v[246:247], v169 offset:7992
    v_and_b32 v155, s61, v117
    v_lshlrev_b32 v156, 16, v118
    v_and_b32 v157, s61, v118
    v_mfma_f32_32x32x16_bf16 v[192:207], v[8:11], v[88:91], v[192:207]
    ds_read_b64_tr_b16 v[248:249], v169 offset:7280
    ds_read_b64_tr_b16 v[250:251], v169 offset:8048
    v_lshlrev_b32 v158, 16, v119
    v_and_b32 v159, s61, v119
    v_fma_f32 v152, v152, v148, v149
    v_mfma_f32_32x32x16_bf16 v[208:223], v[12:15], v[88:91], v[208:223]
    ds_read_b64_tr_b16 v[252:253], v169 offset:35840
    ds_read_b64_tr_b16 v[254:255], v169 offset:36608
    v_fma_f32 v153, v153, v148, v149
    v_fma_f32 v154, v154, v148, v149
    v_fma_f32 v155, v155, v148, v149
    v_mfma_f32_32x32x16_bf16 v[224:239], v[128:131], v[88:91], v[224:239]
    ds_read_b64_tr_b16 v[8:9], v169 offset:35896
    ds_read_b64_tr_b16 v[10:11], v169 offset:36664
    v_fma_f32 v156, v156, v148, v149
    v_fma_f32 v157, v157, v148, v149
    v_fma_f32 v158, v158, v148, v149
    s_waitcnt lgkmcnt(10)
    v_mfma_f32_32x32x16_bf16 v[192:207], v[132:135], v[92:95], v[192:207]
    s_mov_b64 exec, 1
    ds_add_u32 v3, v4 offset:92
    s_mov_b64 exec, -1
    s_nop 0
    ds_read_b64_tr_b16 v[12:13], v169 offset:35952
    ds_read_b64_tr_b16 v[14:15], v169 offset:36720
    v_fma_f32 v159, v159, v148, v149
    v_cvt_pk_bf16_f32 v116, v152, v153
    v_cvt_pk_bf16_f32 v117, v154, v155
    v_mfma_f32_32x32x16_bf16 v[208:223], v[136:139], v[92:95], v[208:223]
    ds_read_b64_tr_b16 v[128:129], v170 offset:7168
    ds_read_b64_tr_b16 v[130:131], v170 offset:7936
    v_cvt_pk_bf16_f32 v118, v156, v157
    v_cvt_pk_bf16_f32 v119, v158, v159
    v_lshlrev_b32_e64 v152, 16, v120
    v_mfma_f32_32x32x16_bf16 v[224:239], v[140:143], v[92:95], v[224:239]
    ds_read_b64_tr_b16 v[132:133], v170 offset:7224
    ds_read_b64_tr_b16 v[134:135], v170 offset:7992
    v_and_b32 v153, s61, v120
    v_lshlrev_b32 v154, 16, v121
    v_and_b32 v155, s61, v121
    s_waitcnt lgkmcnt(11)
    v_mfma_f32_32x32x16_bf16 v[192:207], v[240:243], v[96:99], v[192:207]
    ds_read_b64_tr_b16 v[136:137], v170 offset:7280
    ds_read_b64_tr_b16 v[138:139], v170 offset:8048
    v_lshlrev_b32 v156, 16, v122
    v_and_b32 v157, s61, v122
    v_lshlrev_b32_e64 v158, 16, v123
    v_mfma_f32_32x32x16_bf16 v[208:223], v[244:247], v[96:99], v[208:223]
    ds_read_b64_tr_b16 v[140:141], v170 offset:35840
    ds_read_b64_tr_b16 v[142:143], v170 offset:36608
    v_and_b32_e64 v159, s61, v123
    v_fma_f32 v152, v152, v148, v149
    v_fma_f32 v153, v153, v148, v149
    v_mfma_f32_32x32x16_bf16 v[224:239], v[248:251], v[96:99], v[224:239]
    ds_read_b32 v5, v3 offset:108
    ds_read_b64_tr_b16 v[240:241], v170 offset:35896
    ds_read_b64_tr_b16 v[242:243], v170 offset:36664
    v_fma_f32 v154, v154, v148, v149
    v_fma_f32 v155, v155, v148, v149
    v_fma_f32 v156, v156, v148, v149
    s_waitcnt lgkmcnt(11)
    s_nop 0
    v_mfma_f32_32x32x16_bf16 v[192:207], v[252:255], v[100:103], v[192:207]
    ds_read_b64_tr_b16 v[244:245], v170 offset:35952
    ds_read_b64_tr_b16 v[246:247], v170 offset:36720
    v_fma_f32 v157, v157, v148, v149
    v_fma_f32 v158, v158, v148, v149
    v_fma_f32 v159, v159, v148, v149
    v_mfma_f32_32x32x16_bf16 v[208:223], v[8:11], v[100:103], v[208:223]
    s_waitcnt lgkmcnt(4)
    v_cmp_gt_u32 vcc, 4, v5
    v_cvt_pk_bf16_f32 v120, v152, v153
    v_cvt_pk_bf16_f32 v121, v154, v155
    v_cvt_pk_bf16_f32 v122, v156, v157
    v_mfma_f32_32x32x16_bf16 v[224:239], v[12:15], v[100:103], v[224:239]
    s_cbranch_vccnz L_gq72
L_gq72_x:
    s_nop 0
    ds_read_b64_tr_b16 v[248:249], v169 offset:10240
    ds_read_b64_tr_b16 v[250:251], v169 offset:11008
    ds_read_b64_tr_b16 v[252:253], v169 offset:38912
    ds_read_b64_tr_b16 v[254:255], v169 offset:39680
    v_cvt_pk_bf16_f32 v123, v158, v159
    v_lshlrev_b32 v152, 16, v124
    v_and_b32 v153, s61, v124
    v_mfma_f32_32x32x16_bf16 v[192:207], v[128:131], v[104:107], v[192:207]
    ds_read_b64_tr_b16 v[8:9], v170 offset:10240
    ds_read_b64_tr_b16 v[10:11], v170 offset:11008
    v_lshlrev_b32 v154, 16, v125
    v_and_b32 v155, s61, v125
    v_lshlrev_b32_e64 v156, 16, v126
    v_mfma_f32_32x32x16_bf16 v[208:223], v[132:135], v[104:107], v[208:223]
    ds_read_b64_tr_b16 v[12:13], v170 offset:38912
    ds_read_b64_tr_b16 v[14:15], v170 offset:39680
    v_and_b32 v157, s61, v126
    v_lshlrev_b32 v158, 16, v127
    v_and_b32_e64 v159, s61, v127
    v_mfma_f32_32x32x16_bf16 v[224:239], v[136:139], v[104:107], v[224:239]
    ds_read_b64_tr_b16 v[128:129], v169 offset:10296
    ds_read_b64_tr_b16 v[130:131], v169 offset:11064
    v_fma_f32 v152, v152, v148, v149
    v_fma_f32 v153, v153, v148, v149
    v_fma_f32 v154, v154, v148, v149
    s_waitcnt lgkmcnt(10)
    s_nop 0
    v_mfma_f32_32x32x16_bf16 v[192:207], v[140:143], v[108:111], v[192:207]
    ds_read_b64_tr_b16 v[132:133], v169 offset:38968
    ds_read_b64_tr_b16 v[134:135], v169 offset:39736
    v_fma_f32 v155, v155, v148, v149
    v_fma_f32 v156, v156, v148, v149
    v_fma_f32 v157, v157, v148, v149
    v_mfma_f32_32x32x16_bf16 v[208:223], v[240:243], v[108:111], v[208:223]
    ds_read_b64_tr_b16 v[136:137], v170 offset:10296
    ds_read_b64_tr_b16 v[138:139], v170 offset:11064
    v_fma_f32 v158, v158, v148, v149
    v_fma_f32 v159, v159, v148, v149
    v_cvt_pk_bf16_f32 v124, v152, v153
    v_mfma_f32_32x32x16_bf16 v[224:239], v[244:247], v[108:111], v[224:239]
    ds_read_b64_tr_b16 v[140:141], v170 offset:38968
    ds_read_b64_tr_b16 v[142:143], v170 offset:39736
    v_cvt_pk_bf16_f32 v125, v154, v155
    v_cvt_pk_bf16_f32 v126, v156, v157
    v_cvt_pk_bf16_f32 v127, v158, v159
    s_waitcnt lgkmcnt(10)
    s_nop 0
    v_mfma_f32_32x32x16_bf16 v[192:207], v[248:251], v[112:115], v[192:207]
    ds_read_b64_tr_b16 v[240:241], v169 offset:10352
    ds_read_b64_tr_b16 v[242:243], v169 offset:11120
    v_mfma_f32_32x32x16_bf16 v[192:207], v[252:255], v[116:119], v[192:207]
    ds_read_b64_tr_b16 v[244:245], v169 offset:39024
    ds_read_b64_tr_b16 v[246:247], v169 offset:39792
    v_mfma_f32_32x32x16_bf16 v[192:207], v[8:11], v[120:123], v[192:207]
    ds_read_b32 v5, v3 offset:0
    ds_read_b64_tr_b16 v[248:249], v170 offset:10352
    ds_read_b64_tr_b16 v[250:251], v170 offset:11120
    s_waitcnt lgkmcnt(11)
    v_mfma_f32_32x32x16_bf16 v[192:207], v[12:15], v[124:127], v[192:207]
    ds_read_b64_tr_b16 v[252:253], v170 offset:39024
    ds_read_b64_tr_b16 v[254:255], v170 offset:39792
    v_mfma_f32_32x32x16_bf16 v[208:223], v[128:131], v[112:115], v[208:223]
    s_waitcnt lgkmcnt(4)
    v_cmp_gt_u32_e64 vcc, 4, v5
    v_mfma_f32_32x32x16_bf16 v[208:223], v[132:135], v[116:119], v[208:223]
    s_cbranch_vccnz L_gate0
L_gate0_x:
    s_nop 0
    ds_read_b64_tr_b16 v[8:9], v2 offset:14336
    ds_read_b64_tr_b16 v[10:11], v2 offset:15232
    ds_read_b64_tr_b16 v[12:13], v2 offset:14368
    ds_read_b64_tr_b16 v[14:15], v2 offset:15264
    v_mfma_f32_32x32x16_bf16 v[208:223], v[136:139], v[120:123], v[208:223]
    v_mul_f32 v192, s35, v192
    v_mul_f32 v193, s35, v193
    v_mul_f32 v194, s35, v194
    v_mul_f32 v195, s35, v195
    v_mul_f32 v196, s35, v196
    v_mul_f32 v197, s35, v197
    v_mfma_f32_32x32x16_bf16 v[208:223], v[140:143], v[124:127], v[208:223]
    v_mul_f32 v198, s35, v198
    v_mul_f32 v199, s35, v199
    v_mul_f32 v200, s35, v200
    v_mul_f32 v201, s35, v201
    v_mul_f32 v202, s35, v202
    v_mul_f32 v203, s35, v203
    v_mfma_f32_32x32x16_bf16 v[224:239], v[240:243], v[112:115], v[224:239]
    v_mul_f32 v204, s35, v204
    v_mul_f32 v205, s35, v205
    v_mul_f32 v206, s35, v206
    v_mul_f32 v207, s35, v207
    v_cvt_pk_bf16_f32 v192, v192, v193
    s_waitcnt lgkmcnt(4)
    s_nop 0
    v_mfma_f32_32x32x16_bf16 v[224:239], v[244:247], v[116:119], v[224:239]
    ds_read_b64_tr_b16 v[240:241], v2 offset:14400
    ds_read_b64_tr_b16 v[242:243], v2 offset:15296
    v_cvt_pk_bf16_f32 v193, v194, v195
    v_cvt_pk_bf16_f32 v194, v196, v197
    v_cvt_pk_bf16_f32 v195, v198, v199
    v_cvt_pk_bf16_f32 v196, v200, v201
    v_mfma_f32_32x32x16_bf16 v[224:239], v[248:251], v[120:123], v[224:239]
    ds_read_b64_tr_b16 v[244:245], v2 offset:14432
    ds_read_b64_tr_b16 v[246:247], v2 offset:15328
    v_cvt_pk_bf16_f32 v197, v202, v203
    v_cvt_pk_bf16_f32 v198, v204, v205
    v_cvt_pk_bf16_f32 v199, v206, v207
    v_cndmask_b32 v198, v198, 0, s[42:43]
    v_mfma_f32_32x32x16_bf16 v[224:239], v[252:255], v[124:127], v[224:239]
    ds_read_b64_tr_b16 v[248:249], v2 offset:17920
    ds_read_b64_tr_b16 v[250:251], v2 offset:18816
    v_cndmask_b32 v199, v199, 0, s[42:43]
    v_mul_f32_e64 v208, s36, v208
    v_mul_f32 v209, s36, v209
    s_waitcnt lgkmcnt(6)
    v_mfma_f32_32x32x16_bf16 v[128:143], v[8:11], v[16:19], 0
    buffer_store_dwordx4 v[192:195], v7, s[24:27], s32 offen offset:0 sc1
    v_mfma_f32_32x32x16_bf16 v[144:159], v[12:15], v[16:19], 0
    buffer_store_dwordx4 v[196:199], v7, s[24:27], s32 offen offset:1024 sc1
    s_waitcnt lgkmcnt(2)
    s_nop 0
    v_mfma_f32_32x32x16_bf16 v[160:175], v[240:243], v[16:19], 0
    ds_read_b64_tr_b16 v[252:253], v2 offset:17952
    ds_read_b64_tr_b16 v[254:255], v2 offset:18848
    ds_read_b64_tr_b16 v[8:9], v2 offset:17984
    ds_read_b64_tr_b16 v[10:11], v2 offset:18880
    v_mul_f32 v210, s36, v210
    v_mul_f32 v211, s36, v211
    v_mfma_f32_32x32x16_bf16 v[176:191], v[244:247], v[16:19], 0
    ds_read_b64_tr_b16 v[12:13], v2 offset:18016
    ds_read_b64_tr_b16 v[14:15], v2 offset:18912
    ds_read_b64_tr_b16 v[240:241], v2 offset:14464
    ds_read_b64_tr_b16 v[242:243], v2 offset:15360
    v_mul_f32 v212, s36, v212
    s_waitcnt lgkmcnt(6)
    v_mfma_f32_32x32x16_bf16 v[128:143], v[248:251], v[20:23], v[128:143]
    ds_read_b64_tr_b16 v[244:245], v2 offset:18048
    ds_read_b64_tr_b16 v[246:247], v2 offset:18944
    v_mul_f32 v213, s36, v213
    v_mul_f32 v214, s36, v214
    v_mul_f32 v215, s36, v215
    v_mul_f32 v216, s36, v216
    v_mfma_f32_32x32x16_bf16 v[144:159], v[252:255], v[20:23], v[144:159]
    ds_read_b64_tr_b16 v[248:249], v2 offset:43008
    ds_read_b64_tr_b16 v[250:251], v2 offset:43904
    v_mul_f32 v217, s36, v217
    v_mul_f32 v218, s36, v218
    v_mul_f32 v219, s36, v219
    s_waitcnt lgkmcnt(6)
    v_mfma_f32_32x32x16_bf16 v[160:175], v[8:11], v[20:23], v[160:175]
    ds_read_b64_tr_b16 v[252:253], v2 offset:43040
    ds_read_b64_tr_b16 v[254:255], v2 offset:43936
    v_mul_f32 v220, s36, v220
    v_mul_f32 v221, s36, v221
    v_mul_f32 v222, s36, v222
    v_mul_f32 v223, s36, v223
    v_mfma_f32_32x32x16_bf16 v[176:191], v[12:15], v[20:23], v[176:191]
    ds_read_b64_tr_b16 v[8:9], v2 offset:43072
    ds_read_b64_tr_b16 v[10:11], v2 offset:43968
    v_cvt_pk_bf16_f32 v208, v208, v209
    v_cvt_pk_bf16_f32 v209, v210, v211
    v_cvt_pk_bf16_f32 v210, v212, v213
    s_waitcnt lgkmcnt(6)
    s_nop 0
    v_mfma_f32_32x32x16_bf16 v[192:207], v[240:243], v[16:19], 0
    ds_read_b64_tr_b16 v[12:13], v2 offset:43104
    ds_read_b64_tr_b16 v[14:15], v2 offset:44000
    v_cvt_pk_bf16_f32 v211, v214, v215
    v_cvt_pk_bf16_f32 v212, v216, v217
    v_cvt_pk_bf16_f32 v213, v218, v219
    v_cvt_pk_bf16_f32 v214, v220, v221
    v_mfma_f32_32x32x16_bf16 v[192:207], v[244:247], v[20:23], v[192:207]
    ds_read_b64_tr_b16 v[240:241], v2 offset:43136
    ds_read_b64_tr_b16 v[242:243], v2 offset:44032
    v_cvt_pk_bf16_f32 v215, v222, v223
    v_cndmask_b32 v214, v214, 0, s[42:43]
    v_cndmask_b32 v215, v215, 0, s[42:43]
    s_waitcnt lgkmcnt(6)
    v_mfma_f32_32x32x16_bf16 v[128:143], v[248:251], v[24:27], v[128:143]
    buffer_store_dwordx4 v[208:211], v7, s[24:27], s33 offen offset:0 sc1
    v_mfma_f32_32x32x16_bf16 v[144:159], v[252:255], v[24:27], v[144:159]
    buffer_store_dwordx4 v[212:215], v7, s[24:27], s33 offen offset:1024 sc1
    s_waitcnt lgkmcnt(2)
    v_mfma_f32_32x32x16_bf16 v[160:175], v[8:11], v[24:27], v[160:175]
    ds_read_b64_tr_b16 v[244:245], v2 offset:46592
    ds_read_b64_tr_b16 v[246:247], v2 offset:47488
    ds_read_b64_tr_b16 v[248:249], v2 offset:46624
    ds_read_b64_tr_b16 v[250:251], v2 offset:47520
    v_mul_f32 v224, s37, v224
    v_mul_f32 v225, s37, v225
    v_mfma_f32_32x32x16_bf16 v[176:191], v[12:15], v[24:27], v[176:191]
    ds_read_b32 v5, v3 offset:4
    ds_read_b64_tr_b16 v[252:253], v2 offset:46656
    ds_read_b64_tr_b16 v[254:255], v2 offset:47552
    ds_read_b64_tr_b16 v[8:9], v2 offset:14496
    ds_read_b64_tr_b16 v[10:11], v2 offset:15392
    s_waitcnt lgkmcnt(7)
    v_mfma_f32_32x32x16_bf16 v[192:207], v[240:243], v[24:27], v[192:207]
    ds_read_b64_tr_b16 v[12:13], v2 offset:18080
    ds_read_b64_tr_b16 v[14:15], v2 offset:18976
    v_mul_f32 v226, s37, v226
    v_mul_f32 v227, s37, v227
    v_mul_f32 v228, s37, v228
    v_mul_f32_e64 v229, s37, v229
    v_mfma_f32_32x32x16_bf16 v[128:143], v[244:247], v[28:31], v[128:143]
    s_waitcnt lgkmcnt(6)
    v_cmp_gt_u32 vcc, 4, v5
    ds_read_b64_tr_b16 v[240:241], v2 offset:43168
    ds_read_b64_tr_b16 v[242:243], v2 offset:44064
    v_mul_f32 v230, s37, v230
    s_waitcnt lgkmcnt(6)
    v_mfma_f32_32x32x16_bf16 v[144:159], v[248:251], v[28:31], v[144:159]
    s_cbranch_vccnz L_gate1
L_gate1_x:
    ds_read_b64_tr_b16 v[244:245], v2 offset:46688
    ds_read_b64_tr_b16 v[246:247], v2 offset:47584
    v_mul_f32 v231, s37, v231
    v_mul_f32 v232, s37, v232
    v_mul_f32 v233, s37, v233
    v_mfma_f32_32x32x16_bf16 v[160:175], v[252:255], v[28:31], v[160:175]
    ds_read_b64_tr_b16 v[248:249], v2 offset:46720
    ds_read_b64_tr_b16 v[250:251], v2 offset:47616
    v_mul_f32 v234, s37, v234
    v_mul_f32 v235, s37, v235
    v_mul_f32 v236, s37, v236
    s_waitcnt lgkmcnt(6)
    v_mfma_f32_32x32x16_bf16 v[208:223], v[8:11], v[16:19], 0
    ds_read_b64_tr_b16 v[252:253], v2 offset:46752
    ds_read_b64_tr_b16 v[254:255], v2 offset:47648
    v_mul_f32 v237, s37, v237
    v_mul_f32 v238, s37, v238
    v_mul_f32_e64 v239, s37, v239
    v_cvt_pk_bf16_f32 v224, v224, v225
    v_mfma_f32_32x32x16_bf16 v[208:223], v[12:15], v[20:23], v[208:223]
    ds_read_b64_tr_b16 v[8:9], v2 offset:21504
    ds_read_b64_tr_b16 v[10:11], v2 offset:22400
    v_cvt_pk_bf16_f32 v225, v226, v227
    v_cvt_pk_bf16_f32 v226, v228, v229
    v_cvt_pk_bf16_f32 v227, v230, v231
    s_waitcnt lgkmcnt(6)
    s_nop 0
    v_mfma_f32_32x32x16_bf16 v[208:223], v[240:243], v[24:27], v[208:223]
    ds_read_b64_tr_b16 v[12:13], v2 offset:21536
    ds_read_b64_tr_b16 v[14:15], v2 offset:22432
    v_cvt_pk_bf16_f32 v228, v232, v233
    v_cvt_pk_bf16_f32 v229, v234, v235
    v_cvt_pk_bf16_f32 v230, v236, v237
    v_cvt_pk_bf16_f32 v231, v238, v239
    v_mfma_f32_32x32x16_bf16 v[176:191], v[244:247], v[28:31], v[176:191]
    ds_read_b64_tr_b16 v[240:241], v2 offset:21568
    ds_read_b64_tr_b16 v[242:243], v2 offset:22464
    v_cndmask_b32 v230, v230, 0, s[42:43]
    v_cndmask_b32 v231, v231, 0, s[42:43]
    s_cmp_eq_u32 s60, 10
    s_cbranch_scc1 L_mix
L_mix_x:
    s_waitcnt lgkmcnt(6)
    v_mfma_f32_32x32x16_bf16 v[192:207], v[248:251], v[28:31], v[192:207]
    buffer_store_dwordx4 v[224:227], v7, s[24:27], s34 offen offset:0 sc1
    v_mfma_f32_32x32x16_bf16 v[208:223], v[252:255], v[28:31], v[208:223]
    buffer_store_dwordx4 v[228:231], v7, s[24:27], s34 offen offset:1024 sc1
    s_waitcnt lgkmcnt(2)
    v_mfma_f32_32x32x16_bf16 v[128:143], v[8:11], v[32:35], v[128:143]
    ds_read_b64_tr_b16 v[244:245], v2 offset:21600
    ds_read_b64_tr_b16 v[246:247], v2 offset:22496
    ds_read_b64_tr_b16 v[248:249], v2 offset:14528
    ds_read_b64_tr_b16 v[250:251], v2 offset:15424
    v_mfma_f32_32x32x16_bf16 v[144:159], v[12:15], v[32:35], v[144:159]
    ds_read_b64_tr_b16 v[252:253], v2 offset:18112
    ds_read_b64_tr_b16 v[254:255], v2 offset:19008
    ds_read_b64_tr_b16 v[8:9], v2 offset:43200
    ds_read_b64_tr_b16 v[10:11], v2 offset:44096
    s_waitcnt lgkmcnt(6)
    s_nop 0
    v_mfma_f32_32x32x16_bf16 v[160:175], v[240:243], v[32:35], v[160:175]
    ds_read_b64_tr_b16 v[12:13], v2 offset:46784
    ds_read_b64_tr_b16 v[14:15], v2 offset:47680
    v_mfma_f32_32x32x16_bf16 v[176:191], v[244:247], v[32:35], v[176:191]
    ds_read_b64_tr_b16 v[240:241], v2 offset:21632
    ds_read_b64_tr_b16 v[242:243], v2 offset:22528
    s_waitcnt lgkmcnt(6)
    s_nop 0
    v_mfma_f32_32x32x16_bf16 v[224:239], v[248:251], v[16:19], 0
    ds_read_b64_tr_b16 v[244:245], v2 offset:21664
    ds_read_b64_tr_b16 v[246:247], v2 offset:22560
    v_mfma_f32_32x32x16_bf16 v[224:239], v[252:255], v[20:23], v[224:239]
    ds_read_b64_tr_b16 v[248:249], v2 offset:21696
    ds_read_b64_tr_b16 v[250:251], v2 offset:22592
    ds_read_b64_tr_b16 v[16:17], v2 offset:25088
    ds_read_b64_tr_b16 v[18:19], v2 offset:25984
    s_waitcnt lgkmcnt(8)
    s_nop 0
    v_mfma_f32_32x32x16_bf16 v[224:239], v[8:11], v[24:27], v[224:239]
    ds_read_b64_tr_b16 v[252:253], v2 offset:25120
    ds_read_b64_tr_b16 v[254:255], v2 offset:26016
    ds_read_b64_tr_b16 v[20:21], v2 offset:25152
    ds_read_b64_tr_b16 v[22:23], v2 offset:26048
    v_mfma_f32_32x32x16_bf16 v[224:239], v[12:15], v[28:31], v[224:239]
    s_mov_b64 exec, 1
    ds_add_u32 v3, v4 offset:32
    s_mov_b64 exec, -1
    ds_read_b64_tr_b16 v[8:9], v2 offset:25184
    ds_read_b64_tr_b16 v[10:11], v2 offset:26080
    ds_read_b64_tr_b16 v[24:25], v2 offset:25216
    ds_read_b64_tr_b16 v[26:27], v2 offset:26112
L_pav_x:
    s_waitcnt lgkmcnt(9)
    s_nop 0
    v_mfma_f32_32x32x16_bf16 v[192:207], v[240:243], v[32:35], v[192:207]
    ds_read_b64_tr_b16 v[12:13], v2 offset:25248
    ds_read_b64_tr_b16 v[14:15], v2 offset:26144
    v_mfma_f32_32x32x16_bf16 v[208:223], v[244:247], v[32:35], v[208:223]
    ds_read_b64_tr_b16 v[28:29], v2 offset:25280
    ds_read_b64_tr_b16 v[30:31], v2 offset:26176
    v_mfma_f32_32x32x16_bf16 v[224:239], v[248:251], v[32:35], v[224:239]
    ds_read_b64_tr_b16 v[240:241], v2 offset:50176
    ds_read_b64_tr_b16 v[242:243], v2 offset:51072
    s_lshl_b32 s59, s45, 4
    s_add_u32 s59, s59, s46
    s_lshl_b32 s59, s59, 7
    s_add_u32 s59, s59, 16777216
    v_mfma_f32_32x32x16_bf16 v[128:143], v[16:19], v[36:39], v[128:143]
    ds_read_b64_tr_b16 v[244:245], v2 offset:50208
    ds_read_b64_tr_b16 v[246:247], v2 offset:51104
    v_mov_b32 v6, 0
    s_waitcnt lgkmcnt(8)
    s_nop 0
    v_mfma_f32_32x32x16_bf16 v[144:159], v[252:255], v[36:39], v[144:159]
    ds_read_b64_tr_b16 v[248:249], v2 offset:50240
    ds_read_b64_tr_b16 v[250:251], v2 offset:51136
    v_mfma_f32_32x32x16_bf16 v[160:175], v[20:23], v[36:39], v[160:175]
    ds_read_b64_tr_b16 v[32:33], v2 offset:50272
    ds_read_b64_tr_b16 v[34:35], v2 offset:51168
    v_mfma_f32_32x32x16_bf16 v[176:191], v[8:11], v[36:39], v[176:191]
    ds_read_b64_tr_b16 v[16:17], v2 offset:50304
    ds_read_b64_tr_b16 v[18:19], v2 offset:51200
    v_mfma_f32_32x32x16_bf16 v[192:207], v[24:27], v[36:39], v[192:207]
    ds_read_b64_tr_b16 v[252:253], v2 offset:50336
    ds_read_b64_tr_b16 v[254:255], v2 offset:51232
    s_waitcnt lgkmcnt(8)
    s_nop 0
    v_mfma_f32_32x32x16_bf16 v[208:223], v[12:15], v[36:39], v[208:223]
    ds_read_b64_tr_b16 v[20:21], v2 offset:50368
    ds_read_b64_tr_b16 v[22:23], v2 offset:51264
    v_mfma_f32_32x32x16_bf16 v[224:239], v[28:31], v[36:39], v[224:239]
    ds_read_b64_tr_b16 v[8:9], v2 offset:53760
    ds_read_b64_tr_b16 v[10:11], v2 offset:54656
    v_mfma_f32_32x32x16_bf16 v[128:143], v[240:243], v[40:43], v[128:143]
    ds_read_b64_tr_b16 v[24:25], v2 offset:53792
    ds_read_b64_tr_b16 v[26:27], v2 offset:54688
    v_mfma_f32_32x32x16_bf16 v[144:159], v[244:247], v[40:43], v[144:159]
    ds_read_b64_tr_b16 v[12:13], v2 offset:53824
    ds_read_b64_tr_b16 v[14:15], v2 offset:54720
    s_waitcnt lgkmcnt(8)
    s_nop 0
    v_mfma_f32_32x32x16_bf16 v[160:175], v[248:251], v[40:43], v[160:175]
    ds_read_b64_tr_b16 v[28:29], v2 offset:53856
    ds_read_b64_tr_b16 v[30:31], v2 offset:54752
    v_mfma_f32_32x32x16_bf16 v[176:191], v[32:35], v[40:43], v[176:191]
    ds_read_b32 v5, v3 offset:8
    ds_read_b64_tr_b16 v[36:37], v2 offset:53888
    ds_read_b64_tr_b16 v[38:39], v2 offset:54784
    v_mfma_f32_32x32x16_bf16 v[192:207], v[16:19], v[40:43], v[192:207]
    ds_read_b64_tr_b16 v[240:241], v2 offset:53920
    ds_read_b64_tr_b16 v[242:243], v2 offset:54816
    v_mfma_f32_32x32x16_bf16 v[208:223], v[252:255], v[40:43], v[208:223]
    s_waitcnt lgkmcnt(4)
    v_cmp_gt_u32 vcc, 4, v5
    ds_read_b64_tr_b16 v[244:245], v2 offset:53952
    ds_read_b64_tr_b16 v[246:247], v2 offset:54848
    v_mfma_f32_32x32x16_bf16 v[224:239], v[20:23], v[40:43], v[224:239]
    s_cbranch_vccnz L_gate2
L_gate2_x:
    s_nop 0
    ds_read_b64_tr_b16 v[248:249], v1 offset:0
    ds_read_b64_tr_b16 v[250:251], v1 offset:896
    v_mfma_f32_32x32x16_bf16 v[128:143], v[8:11], v[44:47], v[128:143]
    ds_read_b64_tr_b16 v[32:33], v1 offset:32
    ds_read_b64_tr_b16 v[34:35], v1 offset:928
    v_mfma_f32_32x32x16_bf16 v[144:159], v[24:27], v[44:47], v[144:159]
    ds_read_b64_tr_b16 v[16:17], v1 offset:64
    ds_read_b64_tr_b16 v[18:19], v1 offset:960
    v_mfma_f32_32x32x16_bf16 v[160:175], v[12:15], v[44:47], v[160:175]
    ds_read_b64_tr_b16 v[252:253], v1 offset:96
    ds_read_b64_tr_b16 v[254:255], v1 offset:992
    s_waitcnt lgkmcnt(8)
    s_nop 0
    v_mfma_f32_32x32x16_bf16 v[176:191], v[28:31], v[44:47], v[176:191]
    ds_read_b64_tr_b16 v[20:21], v1 offset:128
    ds_read_b64_tr_b16 v[22:23], v1 offset:1024
    v_mfma_f32_32x32x16_bf16 v[192:207], v[36:39], v[44:47], v[192:207]
    ds_read_b64_tr_b16 v[24:25], v1 offset:160
    ds_read_b64_tr_b16 v[26:27], v1 offset:1056
    v_mfma_f32_32x32x16_bf16 v[208:223], v[240:243], v[44:47], v[208:223]
    s_waitcnt vmcnt(0)
    s_mov_b64 exec, 1
    ds_add_u32 v3, v4 offset:116
    s_mov_b64 exec, -1
    ds_read_b64_tr_b16 v[28:29], v1 offset:192
    ds_read_b64_tr_b16 v[30:31], v1 offset:1088
    v_mfma_f32_32x32x16_bf16 v[224:239], v[244:247], v[44:47], v[224:239]
    s_mov_b64 exec, 1
    ds_add_u32 v3, v4 offset:36
    s_mov_b64 exec, -1
    ds_read_b64_tr_b16 v[36:37], v1 offset:3584
    ds_read_b64_tr_b16 v[38:39], v1 offset:4480
    s_waitcnt lgkmcnt(10)
    v_mfma_f32_32x32x16_bf16 v[128:143], v[248:251], v[48:51], v[128:143]
    ds_read_b64_tr_b16 v[240:241], v1 offset:3616
    ds_read_b64_tr_b16 v[242:243], v1 offset:4512
    v_mfma_f32_32x32x16_bf16 v[144:159], v[32:35], v[48:51], v[144:159]
    ds_read_b64_tr_b16 v[244:245], v1 offset:3648
    ds_read_b64_tr_b16 v[246:247], v1 offset:4544
    v_mfma_f32_32x32x16_bf16 v[160:175], v[16:19], v[48:51], v[160:175]
    ds_read_b64_tr_b16 v[248:249], v1 offset:3680
    ds_read_b64_tr_b16 v[250:251], v1 offset:4576
    v_mfma_f32_32x32x16_bf16 v[176:191], v[252:255], v[48:51], v[176:191]
    ds_read_b64_tr_b16 v[32:33], v1 offset:3712
    ds_read_b64_tr_b16 v[34:35], v1 offset:4608
    s_waitcnt lgkmcnt(8)
    s_nop 0
    v_mfma_f32_32x32x16_bf16 v[192:207], v[20:23], v[48:51], v[192:207]
    ds_read_b64_tr_b16 v[16:17], v1 offset:3744
    ds_read_b64_tr_b16 v[18:19], v1 offset:4640
    v_mfma_f32_32x32x16_bf16 v[208:223], v[24:27], v[48:51], v[208:223]
    ds_read_b64_tr_b16 v[252:253], v1 offset:3776
    ds_read_b64_tr_b16 v[254:255], v1 offset:4672
    v_mfma_f32_32x32x16_bf16 v[224:239], v[28:31], v[48:51], v[224:239]
    ds_read_b64_tr_b16 v[20:21], v1 offset:7168
    ds_read_b64_tr_b16 v[22:23], v1 offset:8064
    v_mfma_f32_32x32x16_bf16 v[128:143], v[36:39], v[52:55], v[128:143]
    ds_read_b64_tr_b16 v[24:25], v1 offset:7200
    ds_read_b64_tr_b16 v[26:27], v1 offset:8096
    s_waitcnt lgkmcnt(8)
    s_nop 0
    v_mfma_f32_32x32x16_bf16 v[144:159], v[240:243], v[52:55], v[144:159]
    ds_read_b64_tr_b16 v[28:29], v1 offset:7232
    ds_read_b64_tr_b16 v[30:31], v1 offset:8128
    v_mfma_f32_32x32x16_bf16 v[160:175], v[244:247], v[52:55], v[160:175]
    ds_read_b64_tr_b16 v[36:37], v1 offset:7264
    ds_read_b64_tr_b16 v[38:39], v1 offset:8160
    v_mfma_f32_32x32x16_bf16 v[176:191], v[248:251], v[52:55], v[176:191]
    ds_read_b64_tr_b16 v[240:241], v1 offset:7296
    ds_read_b64_tr_b16 v[242:243], v1 offset:8192
    v_mfma_f32_32x32x16_bf16 v[192:207], v[32:35], v[52:55], v[192:207]
    ds_read_b64_tr_b16 v[244:245], v1 offset:7328
    ds_read_b64_tr_b16 v[246:247], v1 offset:8224
    s_waitcnt lgkmcnt(8)
    s_nop 0
    v_mfma_f32_32x32x16_bf16 v[208:223], v[16:19], v[52:55], v[208:223]
    ds_read_b64_tr_b16 v[248:249], v1 offset:7360
    ds_read_b64_tr_b16 v[250:251], v1 offset:8256
    v_mfma_f32_32x32x16_bf16 v[224:239], v[252:255], v[52:55], v[224:239]
    ds_read_b64_tr_b16 v[32:33], v1 offset:10752
    ds_read_b64_tr_b16 v[34:35], v1 offset:11648
    v_mfma_f32_32x32x16_bf16 v[128:143], v[20:23], v[56:59], v[128:143]
    ds_read_b64_tr_b16 v[16:17], v1 offset:10784
    ds_read_b64_tr_b16 v[18:19], v1 offset:11680
    v_mfma_f32_32x32x16_bf16 v[144:159], v[24:27], v[56:59], v[144:159]
    ds_read_b64_tr_b16 v[252:253], v1 offset:10816
    ds_read_b64_tr_b16 v[254:255], v1 offset:11712
    s_waitcnt lgkmcnt(8)
    s_nop 0
    v_mfma_f32_32x32x16_bf16 v[160:175], v[28:31], v[56:59], v[160:175]
    ds_read_b64_tr_b16 v[20:21], v1 offset:10848
    ds_read_b64_tr_b16 v[22:23], v1 offset:11744
    v_mfma_f32_32x32x16_bf16 v[176:191], v[36:39], v[56:59], v[176:191]
    ds_read_b32 v5, v3 offset:12
    ds_read_b64_tr_b16 v[24:25], v1 offset:10880
    ds_read_b64_tr_b16 v[26:27], v1 offset:11776
    s_and_b32 s40, s44, 1
    s_lshr_b32 s41, s44, 1
    v_mfma_f32_32x32x16_bf16 v[192:207], v[240:243], v[56:59], v[192:207]
    ds_read_b64_tr_b16 v[28:29], v1 offset:10912
    ds_read_b64_tr_b16 v[30:31], v1 offset:11808
    s_mul_i32 s77, s44, 12288
    s_mul_i32 s65, s52, 147456
    v_mfma_f32_32x32x16_bf16 v[208:223], v[244:247], v[56:59], v[208:223]
    s_waitcnt lgkmcnt(4)
    v_cmp_gt_u32 vcc, 4, v5
    ds_read_b64_tr_b16 v[36:37], v1 offset:10944
    ds_read_b64_tr_b16 v[38:39], v1 offset:11840
    v_mfma_f32_32x32x16_bf16 v[224:239], v[248:251], v[56:59], v[224:239]
    s_cbranch_vccnz L_gate3
L_gate3_x:
    ds_read_b64_tr_b16 v[240:241], v2 offset:0
    ds_read_b64_tr_b16 v[242:243], v2 offset:896
    s_mul_i32 s51, s46, 7168
    s_add_u32 s65, s65, s51
    v_mfma_f32_32x32x16_bf16 v[128:143], v[32:35], v[60:63], v[128:143]
    ds_read_b64_tr_b16 v[244:245], v2 offset:32
    ds_read_b64_tr_b16 v[246:247], v2 offset:928
    s_add_u32 s65, s65, 6291456
    s_add_u32 s66, s65, 4096
    v_mfma_f32_32x32x16_bf16 v[144:159], v[16:19], v[60:63], v[144:159]
    ds_read_b64_tr_b16 v[248:249], v2 offset:64
    ds_read_b64_tr_b16 v[250:251], v2 offset:960
    s_lshl_b32 s46, s50, 7
    s_mul_i32 s0, s44, 401408
    v_mfma_f32_32x32x16_bf16 v[160:175], v[252:255], v[60:63], v[160:175]
    ds_read_b64_tr_b16 v[32:33], v2 offset:96
    ds_read_b64_tr_b16 v[34:35], v2 offset:992
    s_add_u32 s0, s0, s46
    s_mul_i32 s1, s40, 28672
    s_waitcnt lgkmcnt(8)
    v_mfma_f32_32x32x16_bf16 v[176:191], v[20:23], v[60:63], v[176:191]
    ds_read_b64_tr_b16 v[16:17], v2 offset:128
    ds_read_b64_tr_b16 v[18:19], v2 offset:1024
    s_add_u32 s1, s1, 106496
    s_sub_u32 s1, s1, s77
    v_mfma_f32_32x32x16_bf16 v[192:207], v[24:27], v[60:63], v[192:207]
    ds_read_b64_tr_b16 v[252:253], v2 offset:160
    ds_read_b64_tr_b16 v[254:255], v2 offset:1056
    s_mul_i32 s51, s49, 294912
    s_mul_i32 s55, s44, 28672
    v_mfma_f32_32x32x16_bf16 v[208:223], v[28:31], v[60:63], v[208:223]
    ds_read_b64_tr_b16 v[20:21], v2 offset:192
    ds_read_b64_tr_b16 v[22:23], v2 offset:1088
    s_add_u32 s55, s55, s51
    s_nop 0
    s_add_u32 s55, s55, 6291456
    v_mfma_f32_32x32x16_bf16 v[224:239], v[36:39], v[60:63], v[224:239]
    ds_read_b64_tr_b16 v[24:25], v2 offset:3584
    ds_read_b64_tr_b16 v[26:27], v2 offset:4480
    s_mul_i32 s21, s41, 147456
    s_add_u32 s20, s55, s21
    s_waitcnt lgkmcnt(8)
    v_mfma_f32_32x32x16_bf16 v[128:143], v[240:243], v[64:67], v[128:143]
    ds_read_b64_tr_b16 v[28:29], v2 offset:3616
    ds_read_b64_tr_b16 v[30:31], v2 offset:4512
    s_add_u32 s69, s51, s21
    s_sub_u32 s21, s55, s21
    v_mfma_f32_32x32x16_bf16 v[144:159], v[244:247], v[64:67], v[144:159]
    ds_read_b64_tr_b16 v[36:37], v2 offset:3648
    ds_read_b64_tr_b16 v[38:39], v2 offset:4544
    s_add_u32 s21, s21, 147456
    s_lshl_b32 s51, s40, 14
    v_mfma_f32_32x32x16_bf16 v[160:175], v[248:251], v[64:67], v[160:175]
    ds_read_b64_tr_b16 v[240:241], v2 offset:3680
    ds_read_b64_tr_b16 v[242:243], v2 offset:4576
    s_add_u32 s69, s69, s51
    s_add_u32 s69, s69, 6406144
    v_mfma_f32_32x32x16_bf16 v[176:191], v[32:35], v[64:67], v[176:191]
    ds_read_b64_tr_b16 v[244:245], v2 offset:3712
    ds_read_b64_tr_b16 v[246:247], v2 offset:4608
    s_lshr_b32 s68, s49, 1
    s_lshl_b32 s68, s68, 11
    s_waitcnt lgkmcnt(8)
    v_mfma_f32_32x32x16_bf16 v[192:207], v[16:19], v[64:67], v[192:207]
    ds_read_b64_tr_b16 v[248:249], v2 offset:3744
    ds_read_b64_tr_b16 v[250:251], v2 offset:4640
    s_lshl_b32 s51, s44, 9
    s_add_u32 s47, s68, s51
    v_mfma_f32_32x32x16_bf16 v[208:223], v[252:255], v[64:67], v[208:223]
    ds_read_b64_tr_b16 v[32:33], v2 offset:3776
    ds_read_b64_tr_b16 v[34:35], v2 offset:4672
    s_add_u32 s47, s47, 16809984
    s_lshl_b32 s51, s40, 10
    v_mfma_f32_32x32x16_bf16 v[224:239], v[20:23], v[64:67], v[224:239]
    ds_read_b64_tr_b16 v[16:17], v2 offset:28672
    ds_read_b64_tr_b16 v[18:19], v2 offset:29568
    s_add_u32 s68, s68, s51
    s_add_u32 s68, s68, 16842752
    v_mfma_f32_32x32x16_bf16 v[128:143], v[24:27], v[68:71], v[128:143]
    ds_read_b64_tr_b16 v[252:253], v2 offset:28704
    ds_read_b64_tr_b16 v[254:255], v2 offset:29600
    s_lshl_b32 s45, s49, 1
    s_add_u32 s45, s45, s41
    s_waitcnt lgkmcnt(8)
    v_mfma_f32_32x32x16_bf16 v[144:159], v[28:31], v[68:71], v[144:159]
    ds_read_b64_tr_b16 v[20:21], v2 offset:28736
    ds_read_b64_tr_b16 v[22:23], v2 offset:29632
    s_lshl_b32 s45, s45, 5
    s_nop 0
    s_mul_i32 s7, s44, 14336
    v_mfma_f32_32x32x16_bf16 v[160:175], v[36:39], v[68:71], v[160:175]
    ds_read_b64_tr_b16 v[24:25], v2 offset:28768
    ds_read_b64_tr_b16 v[26:27], v2 offset:29664
    s_mul_i32 s6, s44, 100352
    s_add_u32 s6, s6, s46
    v_mfma_f32_32x32x16_bf16 v[176:191], v[240:243], v[68:71], v[176:191]
    ds_read_b64_tr_b16 v[28:29], v2 offset:28800
    ds_read_b64_tr_b16 v[30:31], v2 offset:29696
    s_lshl_b32 s51, s40, 6
    s_add_u32 s46, s46, s51
    v_mfma_f32_32x32x16_bf16 v[192:207], v[244:247], v[68:71], v[192:207]
    ds_read_b64_tr_b16 v[36:37], v2 offset:28832
    ds_read_b64_tr_b16 v[38:39], v2 offset:29728
    s_mov_b32 s51, s64
    s_add_u32 s59, s59, 32768
    s_waitcnt lgkmcnt(8)
    v_mfma_f32_32x32x16_bf16 v[208:223], v[248:251], v[68:71], v[208:223]
    ds_read_b64_tr_b16 v[240:241], v2 offset:28864
    ds_read_b64_tr_b16 v[242:243], v2 offset:29760
    s_lshl_b32 s70, s51, 12
    s_add_u32 s51, s51, 1
    v_mfma_f32_32x32x16_bf16 v[224:239], v[32:35], v[68:71], v[224:239]
    ds_read_b64_tr_b16 v[244:245], v2 offset:32256
    ds_read_b64_tr_b16 v[246:247], v2 offset:33152
    s_cmp_ge_u32 s51, 7
    s_cselect_b32 s51, 0, s51
    v_mfma_f32_32x32x16_bf16 v[128:143], v[16:19], v[72:75], v[128:143]
    ds_read_b64_tr_b16 v[248:249], v2 offset:32288
    ds_read_b64_tr_b16 v[250:251], v2 offset:33184
    s_lshl_b32 s71, s51, 12
    s_add_u32 s51, s51, 1
    v_mfma_f32_32x32x16_bf16 v[144:159], v[252:255], v[72:75], v[144:159]
    ds_read_b64_tr_b16 v[32:33], v2 offset:32320
    ds_read_b64_tr_b16 v[34:35], v2 offset:33216
    s_cmp_ge_u32 s51, 7
    s_cselect_b32 s51, 0, s51
    s_waitcnt lgkmcnt(8)
    v_mfma_f32_32x32x16_bf16 v[160:175], v[20:23], v[72:75], v[160:175]
    ds_read_b64_tr_b16 v[16:17], v2 offset:32352
    ds_read_b64_tr_b16 v[18:19], v2 offset:33248
    s_lshl_b32 s72, s51, 12
    s_add_u32 s51, s51, 1
    v_mfma_f32_32x32x16_bf16 v[176:191], v[24:27], v[72:75], v[176:191]
    ds_read_b32 v5, v3 offset:16
    ds_read_b64_tr_b16 v[252:253], v2 offset:32384
    ds_read_b64_tr_b16 v[254:255], v2 offset:33280
    s_cmp_ge_u32 s51, 7
    s_cselect_b32 s51, 0, s51
    v_mfma_f32_32x32x16_bf16 v[192:207], v[28:31], v[72:75], v[192:207]
    ds_read_b64_tr_b16 v[20:21], v2 offset:32416
    ds_read_b64_tr_b16 v[22:23], v2 offset:33312
    s_lshl_b32 s73, s51, 12
    s_add_u32 s51, s51, 1
    v_mfma_f32_32x32x16_bf16 v[208:223], v[36:39], v[72:75], v[208:223]
    s_waitcnt lgkmcnt(4)
    v_cmp_gt_u32 vcc, 4, v5
    ds_read_b64_tr_b16 v[24:25], v2 offset:32448
    ds_read_b64_tr_b16 v[26:27], v2 offset:33344
    v_mfma_f32_32x32x16_bf16 v[224:239], v[240:243], v[72:75], v[224:239]
    s_cbranch_vccnz L_gate4
L_gate4_x:
    ds_read_b64_tr_b16 v[28:29], v2 offset:7168
    ds_read_b64_tr_b16 v[30:31], v2 offset:8064
    s_cmp_ge_u32 s51, 7
    s_cselect_b32 s51, 0, s51
    v_mfma_f32_32x32x16_bf16 v[128:143], v[244:247], v[76:79], v[128:143]
    ds_read_b64_tr_b16 v[36:37], v2 offset:7200
    ds_read_b64_tr_b16 v[38:39], v2 offset:8096
    s_lshl_b32 s74, s51, 12
    s_add_u32 s51, s51, 1
    v_mfma_f32_32x32x16_bf16 v[144:159], v[248:251], v[76:79], v[144:159]
    ds_read_b64_tr_b16 v[240:241], v2 offset:7232
    ds_read_b64_tr_b16 v[242:243], v2 offset:8128
    s_cmp_ge_u32 s51, 7
    s_cselect_b32 s51, 0, s51
    v_mfma_f32_32x32x16_bf16 v[160:175], v[32:35], v[76:79], v[160:175]
    ds_read_b64_tr_b16 v[244:245], v2 offset:7264
    ds_read_b64_tr_b16 v[246:247], v2 offset:8160
    s_lshl_b32 s75, s51, 12
    s_add_u32 s51, s51, 1
    s_waitcnt lgkmcnt(8)
    v_mfma_f32_32x32x16_bf16 v[176:191], v[16:19], v[76:79], v[176:191]
    ds_read_b64_tr_b16 v[248:249], v2 offset:7296
    ds_read_b64_tr_b16 v[250:251], v2 offset:8192
    s_cmp_ge_u32 s51, 7
    s_cselect_b32 s51, 0, s51
    v_mfma_f32_32x32x16_bf16 v[192:207], v[252:255], v[76:79], v[192:207]
    ds_read_b64_tr_b16 v[32:33], v2 offset:7328
    ds_read_b64_tr_b16 v[34:35], v2 offset:8224
    s_lshl_b32 s76, s51, 12
    s_mov_b32 s28, s16
    v_mfma_f32_32x32x16_bf16 v[208:223], v[20:23], v[76:79], v[208:223]
    ds_read_b64_tr_b16 v[16:17], v2 offset:7360
    ds_read_b64_tr_b16 v[18:19], v2 offset:8256
    s_mov_b32 s29, s17
    s_nop 0
    s_mov_b32 s30, 1605632
    v_mfma_f32_32x32x16_bf16 v[224:239], v[24:27], v[76:79], v[224:239]
    ds_read_b64_tr_b16 v[252:253], v2 offset:10752
    ds_read_b64_tr_b16 v[254:255], v2 offset:11648
    s_mov_b32 s31, 0x00020000
    s_mov_b32 s12, s8
    s_waitcnt lgkmcnt(8)
    v_mfma_f32_32x32x16_bf16 v[128:143], v[28:31], v[80:83], v[128:143]
    ds_read_b64_tr_b16 v[20:21], v2 offset:10784
    ds_read_b64_tr_b16 v[22:23], v2 offset:11680
    s_mov_b32 s13, s9
    s_nop 0
    s_mov_b32 s14, 401408
    v_mfma_f32_32x32x16_bf16 v[144:159], v[36:39], v[80:83], v[144:159]
    ds_read_b64_tr_b16 v[24:25], v2 offset:10816
    ds_read_b64_tr_b16 v[26:27], v2 offset:11712
    s_mov_b32 s15, 0x00020000
    s_mov_b32 s8, s4
    v_mfma_f32_32x32x16_bf16 v[160:175], v[240:243], v[80:83], v[160:175]
    ds_read_b64_tr_b16 v[28:29], v2 offset:10848
    ds_read_b64_tr_b16 v[30:31], v2 offset:11744
    s_mov_b32 s9, s5
    s_mov_b32 s10, 1835008
    v_mfma_f32_32x32x16_bf16 v[176:191], v[244:247], v[80:83], v[176:191]
    ds_read_b64_tr_b16 v[36:37], v2 offset:10880
    ds_read_b64_tr_b16 v[38:39], v2 offset:11776
    s_mov_b32 s11, 0x00020000
    v_lshrrev_b32 v44, 3, v0
    s_waitcnt lgkmcnt(8)
    v_mfma_f32_32x32x16_bf16 v[192:207], v[248:251], v[80:83], v[192:207]
    ds_read_b64_tr_b16 v[240:241], v2 offset:10912
    ds_read_b64_tr_b16 v[242:243], v2 offset:11808
    v_bfe_u32 v47, v0, 4, 1
    v_lshlrev_b32_e64 v45, 2, v47
    v_mfma_f32_32x32x16_bf16 v[208:223], v[32:35], v[80:83], v[208:223]
    ds_read_b64_tr_b16 v[244:245], v2 offset:10944
    ds_read_b64_tr_b16 v[246:247], v2 offset:11840
    v_and_b32 v46, 7, v0
    v_xor_b32 v46, v46, v45
    v_mfma_f32_32x32x16_bf16 v[224:239], v[16:19], v[80:83], v[224:239]
    ds_read_b64_tr_b16 v[248:249], v2 offset:35840
    ds_read_b64_tr_b16 v[250:251], v2 offset:36736
    v_mul_u32_u24 v44, 896, v44
    v_lshl_add_u32 v12, v46, 4, v44
    v_mfma_f32_32x32x16_bf16 v[128:143], v[252:255], v[84:87], v[128:143]
    ds_read_b64_tr_b16 v[32:33], v2 offset:35872
    ds_read_b64_tr_b16 v[34:35], v2 offset:36768
    v_bfe_u32 v44, v0, 2, 2
    v_lshrrev_b32 v48, 5, v0
    s_waitcnt lgkmcnt(8)
    v_mfma_f32_32x32x16_bf16 v[144:159], v[20:23], v[84:87], v[144:159]
    ds_read_b64_tr_b16 v[16:17], v2 offset:35904
    ds_read_b64_tr_b16 v[18:19], v2 offset:36800
    v_lshl_add_u32 v45, v48, 2, v44
    v_lshlrev_b32_e64 v45, 7, v45
    v_mfma_f32_32x32x16_bf16 v[160:175], v[24:27], v[84:87], v[160:175]
    ds_read_b64_tr_b16 v[252:253], v2 offset:35936
    ds_read_b64_tr_b16 v[254:255], v2 offset:36832
    v_and_b32_e64 v46, 3, v0
    v_lshl_add_u32 v45, v46, 3, v45
    v_mfma_f32_32x32x16_bf16 v[176:191], v[28:31], v[84:87], v[176:191]
    ds_read_b64_tr_b16 v[20:21], v2 offset:35968
    ds_read_b64_tr_b16 v[22:23], v2 offset:36864
    v_lshl_add_u32 v45, v47, 5, v45
    v_lshrrev_b32_e64 v44, 1, v44
    v_mfma_f32_32x32x16_bf16 v[192:207], v[36:39], v[84:87], v[192:207]
    ds_read_b64_tr_b16 v[24:25], v2 offset:36000
    ds_read_b64_tr_b16 v[26:27], v2 offset:36896
    v_xor_b32_e64 v44, s40, v44
    v_lshl_add_u32 v45, v44, 6, v45
    s_waitcnt lgkmcnt(8)
    v_mfma_f32_32x32x16_bf16 v[208:223], v[240:243], v[84:87], v[208:223]
    ds_read_b64_tr_b16 v[28:29], v2 offset:36032
    ds_read_b64_tr_b16 v[30:31], v2 offset:36928
    v_add_u32 v8, s77, v45
    v_xor_b32_e64 v9, 64, v8
    v_mfma_f32_32x32x16_bf16 v[224:239], v[244:247], v[84:87], v[224:239]
    ds_read_b64_tr_b16 v[36:37], v2 offset:39424
    ds_read_b64_tr_b16 v[38:39], v2 offset:40320
    v_and_b32 v44, 31, v0
    v_add_u32 v44, s45, v44
    v_mfma_f32_32x32x16_bf16 v[128:143], v[248:251], v[88:91], v[128:143]
    ds_read_b64_tr_b16 v[240:241], v2 offset:39456
    ds_read_b64_tr_b16 v[242:243], v2 offset:40352
    v_mul_u32_u24 v44, 896, v44
    v_lshl_add_u32 v44, v48, 4, v44
    v_mfma_f32_32x32x16_bf16 v[144:159], v[32:35], v[88:91], v[144:159]
    ds_read_b64_tr_b16 v[244:245], v2 offset:39488
    ds_read_b64_tr_b16 v[246:247], v2 offset:40384
    v_add_u32_e64 v6, s46, v44
    v_add_u32 v13, s1, v8
    s_waitcnt lgkmcnt(8)
    v_mfma_f32_32x32x16_bf16 v[160:175], v[16:19], v[88:91], v[160:175]
    ds_read_b64_tr_b16 v[248:249], v2 offset:39520
    ds_read_b64_tr_b16 v[250:251], v2 offset:40416
    v_xor_b32_e64 v14, 64, v13
    v_bfe_u32 v10, v0, 1, 2
    v_mfma_f32_32x32x16_bf16 v[176:191], v[252:255], v[88:91], v[176:191]
    ds_read_b32 v5, v3 offset:20
    ds_read_b64_tr_b16 v[32:33], v2 offset:39552
    ds_read_b64_tr_b16 v[34:35], v2 offset:40448
    v_lshlrev_b32 v10, 7, v10
    v_add_u32 v15, s20, v7
    v_mfma_f32_32x32x16_bf16 v[192:207], v[20:23], v[88:91], v[192:207]
    ds_read_b64_tr_b16 v[16:17], v2 offset:39584
    ds_read_b64_tr_b16 v[18:19], v2 offset:40480
    v_add_u32_e64 v11, s21, v7
    v_mfma_f32_32x32x16_bf16 v[208:223], v[24:27], v[88:91], v[208:223]
    s_waitcnt lgkmcnt(4)
    v_cmp_gt_u32 vcc, 4, v5
    ds_read_b64_tr_b16 v[252:253], v2 offset:39616
    ds_read_b64_tr_b16 v[254:255], v2 offset:40512
    v_mfma_f32_32x32x16_bf16 v[224:239], v[28:31], v[88:91], v[224:239]
    s_cbranch_vccnz L_gate5
L_gate5_x:
    s_nop 0
    ds_read_b64_tr_b16 v[20:21], v2 offset:14336
    ds_read_b64_tr_b16 v[22:23], v2 offset:15232
    v_mfma_f32_32x32x16_bf16 v[128:143], v[36:39], v[92:95], v[128:143]
    ds_read_b64_tr_b16 v[24:25], v2 offset:14368
    ds_read_b64_tr_b16 v[26:27], v2 offset:15264
    v_mfma_f32_32x32x16_bf16 v[144:159], v[240:243], v[92:95], v[144:159]
    ds_read_b64_tr_b16 v[28:29], v2 offset:14400
    ds_read_b64_tr_b16 v[30:31], v2 offset:15296
    v_mfma_f32_32x32x16_bf16 v[160:175], v[244:247], v[92:95], v[160:175]
    ds_read_b64_tr_b16 v[36:37], v2 offset:14432
    ds_read_b64_tr_b16 v[38:39], v2 offset:15328
    s_waitcnt lgkmcnt(8)
    s_nop 0
    v_mfma_f32_32x32x16_bf16 v[176:191], v[248:251], v[92:95], v[176:191]
    ds_read_b64_tr_b16 v[240:241], v2 offset:14464
    ds_read_b64_tr_b16 v[242:243], v2 offset:15360
    v_mfma_f32_32x32x16_bf16 v[192:207], v[32:35], v[92:95], v[192:207]
    ds_read_b64_tr_b16 v[244:245], v2 offset:14496
    ds_read_b64_tr_b16 v[246:247], v2 offset:15392
    v_mfma_f32_32x32x16_bf16 v[208:223], v[16:19], v[92:95], v[208:223]
    ds_read_b64_tr_b16 v[248:249], v2 offset:14528
    ds_read_b64_tr_b16 v[250:251], v2 offset:15424
    v_mfma_f32_32x32x16_bf16 v[224:239], v[252:255], v[92:95], v[224:239]
    ds_read_b64_tr_b16 v[32:33], v2 offset:17920
    ds_read_b64_tr_b16 v[34:35], v2 offset:18816
    s_waitcnt lgkmcnt(8)
    s_nop 0
    v_mfma_f32_32x32x16_bf16 v[128:143], v[20:23], v[96:99], v[128:143]
    ds_read_b64_tr_b16 v[16:17], v2 offset:17952
    ds_read_b64_tr_b16 v[18:19], v2 offset:18848
    v_mfma_f32_32x32x16_bf16 v[144:159], v[24:27], v[96:99], v[144:159]
    ds_read_b64_tr_b16 v[252:253], v2 offset:17984
    ds_read_b64_tr_b16 v[254:255], v2 offset:18880
    v_mfma_f32_32x32x16_bf16 v[160:175], v[28:31], v[96:99], v[160:175]
    ds_read_b64_tr_b16 v[20:21], v2 offset:18016
    ds_read_b64_tr_b16 v[22:23], v2 offset:18912
    v_mfma_f32_32x32x16_bf16 v[176:191], v[36:39], v[96:99], v[176:191]
    ds_read_b64_tr_b16 v[24:25], v2 offset:18048
    ds_read_b64_tr_b16 v[26:27], v2 offset:18944
    s_waitcnt lgkmcnt(8)
    s_nop 0
    v_mfma_f32_32x32x16_bf16 v[192:207], v[240:243], v[96:99], v[192:207]
    ds_read_b64_tr_b16 v[28:29], v2 offset:18080
    ds_read_b64_tr_b16 v[30:31], v2 offset:18976
    v_mfma_f32_32x32x16_bf16 v[208:223], v[244:247], v[96:99], v[208:223]
    ds_read_b64_tr_b16 v[36:37], v2 offset:18112
    ds_read_b64_tr_b16 v[38:39], v2 offset:19008
    v_mfma_f32_32x32x16_bf16 v[224:239], v[248:251], v[96:99], v[224:239]
    ds_read_b64_tr_b16 v[240:241], v2 offset:43008
    ds_read_b64_tr_b16 v[242:243], v2 offset:43904
    v_mfma_f32_32x32x16_bf16 v[128:143], v[32:35], v[100:103], v[128:143]
    ds_read_b64_tr_b16 v[244:245], v2 offset:43040
    ds_read_b64_tr_b16 v[246:247], v2 offset:43936
    s_waitcnt lgkmcnt(8)
    s_nop 0
    v_mfma_f32_32x32x16_bf16 v[144:159], v[16:19], v[100:103], v[144:159]
    ds_read_b64_tr_b16 v[248:249], v2 offset:43072
    ds_read_b64_tr_b16 v[250:251], v2 offset:43968
    v_mfma_f32_32x32x16_bf16 v[160:175], v[252:255], v[100:103], v[160:175]
    ds_read_b64_tr_b16 v[32:33], v2 offset:43104
    ds_read_b64_tr_b16 v[34:35], v2 offset:44000
    v_mfma_f32_32x32x16_bf16 v[176:191], v[20:23], v[100:103], v[176:191]
    ds_read_b64_tr_b16 v[16:17], v2 offset:43136
    ds_read_b64_tr_b16 v[18:19], v2 offset:44032
    v_mfma_f32_32x32x16_bf16 v[192:207], v[24:27], v[100:103], v[192:207]
    ds_read_b64_tr_b16 v[252:253], v2 offset:43168
    ds_read_b64_tr_b16 v[254:255], v2 offset:44064
    s_waitcnt lgkmcnt(8)
    s_nop 0
    v_mfma_f32_32x32x16_bf16 v[208:223], v[28:31], v[100:103], v[208:223]
    ds_read_b64_tr_b16 v[20:21], v2 offset:43200
    ds_read_b64_tr_b16 v[22:23], v2 offset:44096
    v_mfma_f32_32x32x16_bf16 v[224:239], v[36:39], v[100:103], v[224:239]
    ds_read_b64_tr_b16 v[24:25], v2 offset:46592
    ds_read_b64_tr_b16 v[26:27], v2 offset:47488
    v_mfma_f32_32x32x16_bf16 v[128:143], v[240:243], v[104:107], v[128:143]
    ds_read_b64_tr_b16 v[28:29], v2 offset:46624
    ds_read_b64_tr_b16 v[30:31], v2 offset:47520
    v_mfma_f32_32x32x16_bf16 v[144:159], v[244:247], v[104:107], v[144:159]
    ds_read_b64_tr_b16 v[36:37], v2 offset:46656
    ds_read_b64_tr_b16 v[38:39], v2 offset:47552
    s_waitcnt lgkmcnt(8)
    s_nop 0
    v_mfma_f32_32x32x16_bf16 v[160:175], v[248:251], v[104:107], v[160:175]
    ds_read_b64_tr_b16 v[240:241], v2 offset:46688
    ds_read_b64_tr_b16 v[242:243], v2 offset:47584
    v_mfma_f32_32x32x16_bf16 v[176:191], v[32:35], v[104:107], v[176:191]
    ds_read_b32 v5, v3 offset:24
    ds_read_b64_tr_b16 v[244:245], v2 offset:46720
    ds_read_b64_tr_b16 v[246:247], v2 offset:47616
    v_mfma_f32_32x32x16_bf16 v[192:207], v[16:19], v[104:107], v[192:207]
    ds_read_b64_tr_b16 v[248:249], v2 offset:46752
    ds_read_b64_tr_b16 v[250:251], v2 offset:47648
    v_mfma_f32_32x32x16_bf16 v[208:223], v[252:255], v[104:107], v[208:223]
    s_waitcnt lgkmcnt(4)
    v_cmp_gt_u32 vcc, 4, v5
    ds_read_b64_tr_b16 v[32:33], v2 offset:46784
    ds_read_b64_tr_b16 v[34:35], v2 offset:47680
    v_mfma_f32_32x32x16_bf16 v[224:239], v[20:23], v[104:107], v[224:239]
    s_cbranch_vccnz L_gate6
L_gate6_x:
    s_nop 0
    ds_read_b64_tr_b16 v[16:17], v2 offset:21504
    ds_read_b64_tr_b16 v[18:19], v2 offset:22400
    v_mfma_f32_32x32x16_bf16 v[128:143], v[24:27], v[108:111], v[128:143]
    ds_read_b64_tr_b16 v[252:253], v2 offset:25088
    ds_read_b64_tr_b16 v[254:255], v2 offset:25984
    v_mfma_f32_32x32x16_bf16 v[144:159], v[28:31], v[108:111], v[144:159]
    ds_read_b64_tr_b16 v[20:21], v2 offset:50176
    ds_read_b64_tr_b16 v[22:23], v2 offset:51072
    v_mfma_f32_32x32x16_bf16 v[160:175], v[36:39], v[108:111], v[160:175]
    ds_read_b64_tr_b16 v[24:25], v2 offset:53760
    ds_read_b64_tr_b16 v[26:27], v2 offset:54656
    s_waitcnt lgkmcnt(8)
    s_nop 0
    v_mfma_f32_32x32x16_bf16 v[176:191], v[240:243], v[108:111], v[176:191]
    ds_read_b64_tr_b16 v[28:29], v2 offset:21536
    ds_read_b64_tr_b16 v[30:31], v2 offset:22432
    v_mfma_f32_32x32x16_bf16 v[192:207], v[244:247], v[108:111], v[192:207]
    ds_read_b64_tr_b16 v[36:37], v2 offset:25120
    ds_read_b64_tr_b16 v[38:39], v2 offset:26016
    v_mfma_f32_32x32x16_bf16 v[208:223], v[248:251], v[108:111], v[208:223]
    ds_read_b64_tr_b16 v[240:241], v2 offset:50208
    ds_read_b64_tr_b16 v[242:243], v2 offset:51104
    v_mfma_f32_32x32x16_bf16 v[224:239], v[32:35], v[108:111], v[224:239]
    ds_read_b64_tr_b16 v[244:245], v2 offset:53792
    ds_read_b64_tr_b16 v[246:247], v2 offset:54688
    s_waitcnt lgkmcnt(8)
    s_nop 0
    v_mfma_f32_32x32x16_bf16 v[128:143], v[16:19], v[112:115], v[128:143]
    ds_read_b64_tr_b16 v[248:249], v2 offset:21568
    ds_read_b64_tr_b16 v[250:251], v2 offset:22464
    v_mfma_f32_32x32x16_bf16 v[128:143], v[252:255], v[116:119], v[128:143]
    ds_read_b64_tr_b16 v[32:33], v2 offset:25152
    ds_read_b64_tr_b16 v[34:35], v2 offset:26048
    v_mfma_f32_32x32x16_bf16 v[128:143], v[20:23], v[120:123], v[128:143]
    ds_read_b64_tr_b16 v[16:17], v2 offset:50240
    ds_read_b64_tr_b16 v[18:19], v2 offset:51136
    v_mfma_f32_32x32x16_bf16 v[128:143], v[24:27], v[124:127], v[128:143]
    ds_read_b64_tr_b16 v[252:253], v2 offset:53824
    ds_read_b64_tr_b16 v[254:255], v2 offset:54720
    s_waitcnt lgkmcnt(8)
    s_nop 0
    v_mfma_f32_32x32x16_bf16 v[144:159], v[28:31], v[112:115], v[144:159]
    ds_read_b64_tr_b16 v[20:21], v2 offset:21600
    ds_read_b64_tr_b16 v[22:23], v2 offset:22496
    v_mfma_f32_32x32x16_bf16 v[144:159], v[36:39], v[116:119], v[144:159]
    ds_read_b64_tr_b16 v[24:25], v2 offset:25184
    ds_read_b64_tr_b16 v[26:27], v2 offset:26080
    v_mfma_f32_32x32x16_bf16 v[144:159], v[240:243], v[120:123], v[144:159]
    ds_read_b64_tr_b16 v[28:29], v2 offset:50272
    ds_read_b64_tr_b16 v[30:31], v2 offset:51168
    v_max_f32 v128, 0, v128
    v_max_f32 v129, 0, v129
    v_max_f32 v130, 0, v130
    v_max_f32 v131, 0, v131
    v_mfma_f32_32x32x16_bf16 v[144:159], v[244:247], v[124:127], v[144:159]
    ds_read_b64_tr_b16 v[36:37], v2 offset:53856
    ds_read_b64_tr_b16 v[38:39], v2 offset:54752
    v_max_f32 v132, 0, v132
    v_max_f32 v133, 0, v133
    v_max_f32 v134, 0, v134
    s_waitcnt lgkmcnt(8)
    v_mfma_f32_32x32x16_bf16 v[160:175], v[248:251], v[112:115], v[160:175]
    ds_read_b64_tr_b16 v[240:241], v2 offset:21632
    ds_read_b64_tr_b16 v[242:243], v2 offset:22528
    v_max_f32 v135, 0, v135
    v_mul_f32 v128, v128, v136
    v_mul_f32 v129, v129, v137
    v_mul_f32 v130, v130, v138
    v_mfma_f32_32x32x16_bf16 v[160:175], v[32:35], v[116:119], v[160:175]
    ds_read_b64_tr_b16 v[244:245], v2 offset:25216
    ds_read_b64_tr_b16 v[246:247], v2 offset:26112
    v_mul_f32 v131, v131, v139
    v_mul_f32 v132, v132, v140
    v_mul_f32 v133, v133, v141
    v_mul_f32 v134, v134, v142
    v_mfma_f32_32x32x16_bf16 v[160:175], v[16:19], v[120:123], v[160:175]
    ds_read_b64_tr_b16 v[248:249], v2 offset:50304
    ds_read_b64_tr_b16 v[250:251], v2 offset:51200
    v_mul_f32_e64 v135, v135, v143
    v_cvt_pk_bf16_f32 v52, v128, v129
    v_cvt_pk_bf16_f32 v53, v130, v131
    v_cvt_pk_bf16_f32 v54, v132, v133
    v_mfma_f32_32x32x16_bf16 v[160:175], v[252:255], v[124:127], v[160:175]
    ds_read_b64_tr_b16 v[32:33], v2 offset:53888
    ds_read_b64_tr_b16 v[34:35], v2 offset:54784
    v_cvt_pk_bf16_f32 v55, v134, v135
    v_max_f32_e64 v144, 0, v144
    v_max_f32 v145, 0, v145
    s_waitcnt lgkmcnt(8)
    v_mfma_f32_32x32x16_bf16 v[176:191], v[20:23], v[112:115], v[176:191]
    ds_read_b64_tr_b16 v[16:17], v2 offset:21664
    ds_read_b64_tr_b16 v[18:19], v2 offset:22560
    v_max_f32 v146, 0, v146
    v_max_f32 v147, 0, v147
    v_max_f32 v148, 0, v148
    v_max_f32 v149, 0, v149
    v_mfma_f32_32x32x16_bf16 v[176:191], v[24:27], v[116:119], v[176:191]
    ds_read_b64_tr_b16 v[252:253], v2 offset:25248
    ds_read_b64_tr_b16 v[254:255], v2 offset:26144
    v_max_f32 v150, 0, v150
    v_max_f32 v151, 0, v151
    v_mul_f32 v144, v144, v152
    v_mul_f32 v145, v145, v153
    v_mfma_f32_32x32x16_bf16 v[176:191], v[28:31], v[120:123], v[176:191]
    ds_read_b64_tr_b16 v[20:21], v2 offset:50336
    ds_read_b64_tr_b16 v[22:23], v2 offset:51232
    v_mul_f32 v146, v146, v154
    v_mul_f32 v147, v147, v155
    v_mul_f32 v148, v148, v156
    v_mul_f32 v149, v149, v157
    v_mfma_f32_32x32x16_bf16 v[176:191], v[36:39], v[124:127], v[176:191]
    ds_read_b64_tr_b16 v[24:25], v2 offset:53920
    ds_read_b64_tr_b16 v[26:27], v2 offset:54816
    v_mul_f32 v150, v150, v158
    v_mul_f32 v151, v151, v159
    v_cvt_pk_bf16_f32 v56, v144, v145
    s_waitcnt lgkmcnt(8)
    s_nop 0
    v_mfma_f32_32x32x16_bf16 v[192:207], v[240:243], v[112:115], v[192:207]
    ds_read_b64_tr_b16 v[28:29], v2 offset:21696
    ds_read_b64_tr_b16 v[30:31], v2 offset:22592
    v_cvt_pk_bf16_f32 v57, v146, v147
    v_cvt_pk_bf16_f32 v58, v148, v149
    v_cvt_pk_bf16_f32 v59, v150, v151
    v_max_f32_e64 v160, 0, v160
    v_mfma_f32_32x32x16_bf16 v[192:207], v[244:247], v[116:119], v[192:207]
    ds_read_b64_tr_b16 v[36:37], v2 offset:25280
    ds_read_b64_tr_b16 v[38:39], v2 offset:26176
    v_max_f32 v161, 0, v161
    v_max_f32 v162, 0, v162
    v_max_f32 v163, 0, v163
    v_max_f32 v164, 0, v164
    v_mfma_f32_32x32x16_bf16 v[192:207], v[248:251], v[120:123], v[192:207]
    ds_read_b64_tr_b16 v[240:241], v2 offset:50368
    ds_read_b64_tr_b16 v[242:243], v2 offset:51264
    v_max_f32 v165, 0, v165
    v_max_f32 v166, 0, v166
    v_max_f32 v167, 0, v167
    v_mul_f32 v160, v160, v168
    v_mfma_f32_32x32x16_bf16 v[192:207], v[32:35], v[124:127], v[192:207]
    ds_read_b64_tr_b16 v[244:245], v2 offset:53952
    ds_read_b64_tr_b16 v[246:247], v2 offset:54848
    v_mul_f32 v161, v161, v169
    v_mul_f32 v162, v162, v170
    v_mul_f32 v163, v163, v171
    s_waitcnt lgkmcnt(8)
    v_mfma_f32_32x32x16_bf16 v[208:223], v[16:19], v[112:115], v[208:223]
    v_mul_f32 v164, v164, v172
    v_mul_f32 v165, v165, v173
    v_mul_f32 v166, v166, v174
    v_mul_f32 v167, v167, v175
    v_cvt_pk_bf16_f32 v60, v160, v161
    v_cvt_pk_bf16_f32 v61, v162, v163
    v_mfma_f32_32x32x16_bf16 v[208:223], v[252:255], v[116:119], v[208:223]
    v_cvt_pk_bf16_f32 v62, v164, v165
    v_cvt_pk_bf16_f32 v63, v166, v167
    v_max_f32 v176, 0, v176
    v_max_f32 v177, 0, v177
    v_max_f32 v178, 0, v178
    v_max_f32 v179, 0, v179
    v_mfma_f32_32x32x16_bf16 v[208:223], v[20:23], v[120:123], v[208:223]
    v_max_f32 v180, 0, v180
    v_max_f32 v181, 0, v181
    v_max_f32 v182, 0, v182
    v_max_f32 v183, 0, v183
    v_mul_f32 v176, v176, v184
    v_mul_f32 v177, v177, v185
    v_mfma_f32_32x32x16_bf16 v[208:223], v[24:27], v[124:127], v[208:223]
    v_mul_f32 v178, v178, v186
    v_mul_f32 v179, v179, v187
    v_mul_f32 v180, v180, v188
    v_mul_f32 v181, v181, v189
    v_mul_f32 v182, v182, v190
    s_waitcnt lgkmcnt(4)
    v_mfma_f32_32x32x16_bf16 v[224:239], v[28:31], v[112:115], v[224:239]
    v_mul_f32_e64 v183, v183, v191
    v_cvt_pk_bf16_f32 v64, v176, v177
    v_cvt_pk_bf16_f32 v65, v178, v179
    v_cvt_pk_bf16_f32 v66, v180, v181
    v_cvt_pk_bf16_f32 v67, v182, v183
    v_max_f32_e64 v192, 0, v192
    v_mfma_f32_32x32x16_bf16 v[224:239], v[36:39], v[116:119], v[224:239]
    v_max_f32 v193, 0, v193
    v_max_f32 v194, 0, v194
    v_max_f32 v195, 0, v195
    v_max_f32 v196, 0, v196
    v_max_f32 v197, 0, v197
    s_waitcnt lgkmcnt(0)
    v_mfma_f32_32x32x16_bf16 v[224:239], v[240:243], v[120:123], v[224:239]
    v_max_f32 v198, 0, v198
    v_max_f32 v199, 0, v199
    v_mul_f32 v192, v192, v200
    v_mul_f32 v193, v193, v201
    v_mul_f32 v194, v194, v202
    v_mul_f32 v195, v195, v203
    v_mfma_f32_32x32x16_bf16 v[224:239], v[244:247], v[124:127], v[224:239]
    v_mul_f32 v196, v196, v204
    v_mul_f32 v197, v197, v205
    v_mul_f32 v198, v198, v206
    v_mul_f32 v199, v199, v207
    v_cvt_pk_bf16_f32 v68, v192, v193
    s_mov_b64 exec, 1
    ds_add_u32 v3, v4 offset:48
    s_mov_b64 exec, -1
    v_cvt_pk_bf16_f32 v69, v194, v195
    v_cvt_pk_bf16_f32 v70, v196, v197
    v_cvt_pk_bf16_f32 v71, v198, v199
    v_max_f32 v208, 0, v208
    v_max_f32 v209, 0, v209
    v_max_f32 v210, 0, v210
    v_max_f32 v211, 0, v211
    v_max_f32 v212, 0, v212
    v_max_f32 v213, 0, v213
    v_max_f32 v214, 0, v214
    v_max_f32 v215, 0, v215
    v_mul_f32 v208, v208, v216
    v_mul_f32 v209, v209, v217
    v_mul_f32 v210, v210, v218
    v_mul_f32 v211, v211, v219
    v_mul_f32 v212, v212, v220
    v_mul_f32 v213, v213, v221
    v_mul_f32 v214, v214, v222
    v_mul_f32 v215, v215, v223
    v_cvt_pk_bf16_f32 v72, v208, v209
    v_cvt_pk_bf16_f32 v73, v210, v211
    v_cvt_pk_bf16_f32 v74, v212, v213
    v_cvt_pk_bf16_f32 v75, v214, v215
    v_add_u32 v2, 6144, v12
    v_mov_b32 v1, 0
    s_nop 5
    v_max_f32 v224, 0, v224
    v_max_f32 v225, 0, v225
    v_max_f32 v226, 0, v226
    v_max_f32 v227, 0, v227
    v_max_f32 v228, 0, v228
    v_max_f32 v229, 0, v229
    v_max_f32 v230, 0, v230
    v_max_f32 v231, 0, v231
    v_mul_f32 v224, v224, v232
    v_mul_f32 v225, v225, v233
    v_mul_f32 v226, v226, v234
    v_mul_f32 v227, v227, v235
    v_mul_f32 v228, v228, v236
    v_mul_f32 v229, v229, v237
    v_mul_f32 v230, v230, v238
    v_mul_f32 v231, v231, v239
    v_cvt_pk_bf16_f32 v76, v224, v225
    v_cvt_pk_bf16_f32 v77, v226, v227
    v_cvt_pk_bf16_f32 v78, v228, v229
    v_cvt_pk_bf16_f32 v79, v230, v231
L_ha:
    s_sleep 2
    ds_read_b32 v5, v3 offset:52
    s_waitcnt lgkmcnt(0)
    v_cmp_gt_u32 vcc, 4, v5
    s_nop 3
    s_cbranch_vccnz L_ha
    s_cmp_lt_u32 s50, 7
    s_cbranch_scc1 L_htile
    s_mov_b64 exec, 1
    ds_add_u32 v3, v4 offset:100
    s_mov_b64 exec, -1
    buffer_store_dwordx4 v[52:55], v7, s[24:27], s65 offen offset:0 sc1
    buffer_store_dwordx4 v[56:59], v7, s[24:27], s65 offen offset:1024 sc1
    s_waitcnt vmcnt(1)
    buffer_store_dwordx4 v[60:63], v7, s[24:27], s65 offen offset:2048 sc1
    s_waitcnt vmcnt(1)
    buffer_store_dwordx4 v[64:67], v7, s[24:27], s65 offen offset:3072 sc1
    s_waitcnt vmcnt(1)
    buffer_store_dwordx4 v[68:71], v7, s[24:27], s66 offen offset:0 sc1
    s_waitcnt vmcnt(1)
    buffer_store_dwordx4 v[72:75], v7, s[24:27], s66 offen offset:1024 sc1
    s_waitcnt vmcnt(1)
    buffer_store_dwordx4 v[76:79], v7, s[24:27], s66 offen offset:2048 sc1
    s_waitcnt vmcnt(0)
    s_mov_b64 exec, 1
    ds_add_rtn_u32 v1, v3, v4 offset:120
    s_mov_b64 exec, -1
    s_waitcnt lgkmcnt(0)
    v_xor_b32 v1, 3, v1
    v_lshlrev_b32 v1, 25, v1
    buffer_store_dword v4, v1, s[24:27], s59 offen sc1
    s_branch L_h_end
L_htile:
    buffer_load_dwordx4 v[80:83], v6, s[8:11], 0 offen offset:0
    buffer_load_dwordx4 v[84:87], v6, s[8:11], 0 offen offset:32
L_hdh:
    ds_read_b32 v5, v3 offset:48
    s_waitcnt lgkmcnt(0)
    v_cmp_gt_u32_e64 vcc, 4, v5
    s_nop 3
    s_cbranch_vccnz L_hdh
    buffer_store_dwordx4 v[52:55], v7, s[24:27], s65 offen offset:0 sc1
    s_add_u32 m0, s77, 0
    s_mul_i32 s4, s70, 14
    s_add_u32 s4, s4, s0
    buffer_load_dwordx4 v12, s[28:31], s4 offen lds
    s_waitcnt vmcnt(3)
    buffer_load_dwordx4 v2, s[28:31], s4 offen offset:1024 lds
    s_waitcnt vmcnt(3)
    buffer_store_dwordx4 v[56:59], v7, s[24:27], s65 offen offset:1024 sc1
    s_waitcnt vmcnt(3)
    s_add_u32 m0, s77, 2048
    s_mul_i32 s4, s70, 14
    s_add_u32 s4, s4, s0
    s_add_u32 s4, s4, 14336
    buffer_load_dwordx4 v12, s[28:31], s4 offen lds
    s_waitcnt vmcnt(3)
    buffer_load_dwordx4 v2, s[28:31], s4 offen offset:1024 lds
    s_waitcnt vmcnt(3)
    buffer_store_dwordx4 v[60:63], v7, s[24:27], s65 offen offset:2048 sc1
    s_waitcnt vmcnt(3)
    s_add_u32 m0, s77, 4096
    s_mul_i32 s4, s70, 14
    s_add_u32 s4, s4, s0
    s_add_u32 s4, s4, 28672
    buffer_load_dwordx4 v12, s[28:31], s4 offen lds
    s_waitcnt vmcnt(3)
    buffer_load_dwordx4 v2, s[28:31], s4 offen offset:1024 lds
    s_waitcnt vmcnt(3)
    buffer_store_dwordx4 v[64:67], v7, s[24:27], s65 offen offset:3072 sc1
    s_waitcnt vmcnt(3)
    s_add_u32 m0, s77, 6144
    s_mul_i32 s4, s70, 14
    s_add_u32 s4, s4, s0
    s_add_u32 s4, s4, 43008
    buffer_load_dwordx4 v12, s[28:31], s4 offen lds
    s_waitcnt vmcnt(3)
    buffer_load_dwordx4 v2, s[28:31], s4 offen offset:1024 lds
    v_permlane32_swap_b32 v80, v82
    v_permlane32_swap_b32 v81, v83
    v_permlane32_swap_b32 v84, v86
    v_permlane32_swap_b32 v85, v87
    s_mov_b32 s51, 0xffff0000
    v_lshlrev_b32 v16, 16, v80
    v_and_b32 v17, s51, v80
    v_lshlrev_b32 v18, 16, v81
    v_and_b32 v19, s51, v81
    v_lshlrev_b32 v20, 16, v82
    v_and_b32 v21, s51, v82
    v_lshlrev_b32 v22, 16, v83
    v_and_b32 v23, s51, v83
    v_lshlrev_b32 v24, 16, v84
    v_and_b32 v25, s51, v84
    v_lshlrev_b32 v26, 16, v85
    v_and_b32 v27, s51, v85
    v_lshlrev_b32 v28, 16, v86
    v_and_b32 v29, s51, v86
    v_lshlrev_b32 v30, 16, v87
    v_and_b32_e64 v31, s51, v87
    s_mov_b32 s8, s18
    s_mov_b32 s9, s19
    s_mov_b32 s10, 1835008
    s_mov_b32 s11, 0x00020000
    s_waitcnt vmcnt(3)
    buffer_store_dwordx4 v[68:71], v7, s[24:27], s66 offen offset:0 sc1
    s_waitcnt vmcnt(3)
    s_add_u32 m0, s77, 8192
    s_mul_i32 s4, s71, 14
    s_add_u32 s4, s4, s0
    buffer_load_dwordx4 v12, s[28:31], s4 offen lds
    s_waitcnt vmcnt(3)
    buffer_load_dwordx4 v2, s[28:31], s4 offen offset:1024 lds
    s_waitcnt vmcnt(3)
    buffer_store_dwordx4 v[72:75], v7, s[24:27], s66 offen offset:1024 sc1
    s_waitcnt vmcnt(3)
    s_add_u32 m0, s77, 10240
    s_mul_i32 s4, s71, 14
    s_add_u32 s4, s4, s0
    s_add_u32 s4, s4, 14336
    buffer_load_dwordx4 v12, s[28:31], s4 offen lds
    s_waitcnt vmcnt(3)
    buffer_load_dwordx4 v2, s[28:31], s4 offen offset:1024 lds
    s_waitcnt vmcnt(3)
    buffer_store_dwordx4 v[76:79], v7, s[24:27], s66 offen offset:2048 sc1
    s_waitcnt vmcnt(3)
    s_add_u32 m0, s77, 49152
    s_mul_i32 s4, s71, 14
    s_add_u32 s4, s4, s0
    s_add_u32 s4, s4, 28672
    buffer_load_dwordx4 v12, s[28:31], s4 offen lds
    s_waitcnt vmcnt(3)
    buffer_load_dwordx4 v2, s[28:31], s4 offen offset:1024 lds
    s_waitcnt vmcnt(3)
    s_add_u32 m0, s77, 51200
    s_mul_i32 s4, s71, 14
    s_add_u32 s4, s4, s0
    s_add_u32 s4, s4, 43008
    buffer_load_dwordx4 v12, s[28:31], s4 offen lds
    s_waitcnt vmcnt(3)
    buffer_load_dwordx4 v2, s[28:31], s4 offen offset:1024 lds
    s_mov_b64 exec, 1
    ds_add_rtn_u32 v1, v3, v4 offset:120
    s_mov_b64 exec, -1
    s_waitcnt lgkmcnt(0)
    v_xor_b32 v1, 3, v1
    v_lshlrev_b32 v1, 25, v1
    buffer_store_dword v4, v1, s[24:27], s59 offen sc1
    s_waitcnt vmcnt(3)
    s_add_u32 m0, s77, 53248
    s_mul_i32 s4, s72, 14
    s_add_u32 s4, s4, s0
    buffer_load_dwordx4 v12, s[28:31], s4 offen lds
    s_waitcnt vmcnt(3)
    buffer_load_dwordx4 v2, s[28:31], s4 offen offset:1024 lds
    ds_read_b64_tr_b16 v[128:129], v8 offset:49152
    ds_read_b64_tr_b16 v[130:131], v8 offset:50176
    ds_read_b64_tr_b16 v[132:133], v9 offset:49152
    ds_read_b64_tr_b16 v[134:135], v9 offset:50176
    s_add_u32 m0, s77, 55296
    s_mul_i32 s4, s72, 14
    s_add_u32 s4, s4, s0
    s_add_u32 s4, s4, 14336
    buffer_load_dwordx4 v12, s[28:31], s4 offen lds
    buffer_load_dwordx4 v2, s[28:31], s4 offen offset:1024 lds
    s_waitcnt vmcnt(5)
    s_add_u32 m0, s77, 57344
    s_mul_i32 s4, s72, 14
    s_add_u32 s4, s4, s0
    s_add_u32 s4, s4, 28672
    buffer_load_dwordx4 v12, s[28:31], s4 offen lds
    s_waitcnt vmcnt(5)
    buffer_load_dwordx4 v2, s[28:31], s4 offen offset:1024 lds
    ds_read_b64_tr_b16 v[136:137], v8 offset:51200
    ds_read_b64_tr_b16 v[138:139], v8 offset:52224
    ds_read_b64_tr_b16 v[140:141], v9 offset:51200
    ds_read_b64_tr_b16 v[142:143], v9 offset:52224
    s_waitcnt vmcnt(5)
    s_add_u32 m0, s77, 59392
    s_mul_i32 s4, s72, 14
    s_add_u32 s4, s4, s0
    s_add_u32 s4, s4, 43008
    buffer_load_dwordx4 v12, s[28:31], s4 offen lds
    s_waitcnt vmcnt(5)
    buffer_load_dwordx4 v2, s[28:31], s4 offen offset:1024 lds
    ds_read_b64_tr_b16 v[144:145], v8 offset:53248
    ds_read_b64_tr_b16 v[146:147], v8 offset:54272
    ds_read_b64_tr_b16 v[148:149], v9 offset:53248
    ds_read_b64_tr_b16 v[150:151], v9 offset:54272
    s_waitcnt lgkmcnt(8)
    s_waitcnt vmcnt(5)
    s_add_u32 m0, s77, 49152
    s_mul_i32 s4, s73, 14
    s_add_u32 s4, s4, s0
    buffer_load_dwordx4 v12, s[28:31], s4 offen lds
    s_waitcnt vmcnt(5)
    s_nop 0
    buffer_load_dwordx4 v2, s[28:31], s4 offen offset:1024 lds
    ds_read_b64_tr_b16 v[152:153], v8 offset:55296
    ds_read_b64_tr_b16 v[154:155], v8 offset:56320
    ds_read_b64_tr_b16 v[156:157], v9 offset:55296
    ds_read_b64_tr_b16 v[158:159], v9 offset:56320
    s_waitcnt lgkmcnt(8)
    s_waitcnt vmcnt(5)
    s_add_u32 m0, s77, 51200
    s_mul_i32 s4, s73, 14
    s_add_u32 s4, s4, s0
    s_add_u32 s4, s4, 14336
    buffer_load_dwordx4 v12, s[28:31], s4 offen lds
    s_waitcnt vmcnt(5)
    s_nop 0
    buffer_load_dwordx4 v2, s[28:31], s4 offen offset:1024 lds
    ds_read_b64_tr_b16 v[160:161], v8 offset:57344
    ds_read_b64_tr_b16 v[162:163], v8 offset:58368
    ds_read_b64_tr_b16 v[164:165], v9 offset:57344
    ds_read_b64_tr_b16 v[166:167], v9 offset:58368
    s_waitcnt lgkmcnt(8)
    s_waitcnt vmcnt(5)
    s_add_u32 m0, s77, 53248
    s_mul_i32 s4, s73, 14
    s_add_u32 s4, s4, s0
    s_add_u32 s4, s4, 28672
    buffer_load_dwordx4 v12, s[28:31], s4 offen lds
    s_waitcnt vmcnt(5)
    s_nop 0
    buffer_load_dwordx4 v2, s[28:31], s4 offen offset:1024 lds
    ds_read_b64_tr_b16 v[168:169], v8 offset:59392
    ds_read_b64_tr_b16 v[170:171], v8 offset:60416
    ds_read_b64_tr_b16 v[172:173], v9 offset:59392
    ds_read_b64_tr_b16 v[174:175], v9 offset:60416
    s_waitcnt lgkmcnt(8)
    s_waitcnt vmcnt(5)
    s_add_u32 m0, s77, 55296
    s_mul_i32 s4, s73, 14
    s_add_u32 s4, s4, s0
    s_add_u32 s4, s4, 43008
    buffer_load_dwordx4 v12, s[28:31], s4 offen lds
    s_waitcnt vmcnt(5)
    s_nop 0
    buffer_load_dwordx4 v2, s[28:31], s4 offen offset:1024 lds
    ds_read_b64_tr_b16 v[176:177], v8 offset:49152
    ds_read_b64_tr_b16 v[178:179], v8 offset:50176
    ds_read_b64_tr_b16 v[180:181], v9 offset:49152
    ds_read_b64_tr_b16 v[182:183], v9 offset:50176
    s_mov_b32 s62, 0
L_p2:
    buffer_load_dword v5, v10, s[24:27], s47 offen sc1
    s_add_u32 s62, s62, 1
    s_waitcnt vmcnt(0)
    v_cmp_le_u32 vcc, 1, v5
    s_cmp_gt_u32 s62, 65536
    s_cbranch_scc1 L_p2_x
    s_nop 1
    s_cmp_eq_u64 vcc, -1
    s_cbranch_scc1 L_p2_x
    s_sleep 8
    s_branch L_p2
L_p2_x:
    v_and_b32_e64 v10, 7, v0
    v_lshlrev_b32 v10, 7, v10
    s_setprio 0
    buffer_load_dwordx4 v[80:83], v15, s[24:27], s70 offen offset:0 sc1
    s_waitcnt lgkmcnt(0)
    s_nop 0
    ds_read_b64_tr_b16 v[184:185], v8 offset:51200
    ds_read_b64_tr_b16 v[186:187], v8 offset:52224
    ds_read_b64_tr_b16 v[188:189], v9 offset:51200
    ds_read_b64_tr_b16 v[190:191], v9 offset:52224
    ds_read_b64_tr_b16 v[192:193], v8 offset:53248
    ds_read_b64_tr_b16 v[194:195], v8 offset:54272
    ds_read_b64_tr_b16 v[196:197], v9 offset:53248
    ds_read_b64_tr_b16 v[198:199], v9 offset:54272
    ds_read_b64_tr_b16 v[200:201], v8 offset:55296
    ds_read_b64_tr_b16 v[202:203], v8 offset:56320
    ds_read_b64_tr_b16 v[204:205], v9 offset:55296
    ds_read_b64_tr_b16 v[206:207], v9 offset:56320
    buffer_load_dwordx4 v[84:87], v11, s[24:27], s70 offen offset:0 sc1
    buffer_load_dwordx4 v[88:91], v15, s[24:27], s70 offen offset:1024 sc1
    buffer_load_dwordx4 v[92:95], v11, s[24:27], s70 offen offset:1024 sc1
    buffer_load_dwordx4 v[96:99], v15, s[24:27], s70 offen offset:2048 sc1
    s_waitcnt vmcnt(4)
    buffer_load_dwordx4 v[100:103], v11, s[24:27], s70 offen offset:2048 sc1
    s_waitcnt vmcnt(4)
    buffer_load_dwordx4 v[104:107], v15, s[24:27], s70 offen offset:3072 sc1
    s_waitcnt vmcnt(4)
    buffer_load_dwordx4 v[108:111], v11, s[24:27], s70 offen offset:3072 sc1
    s_waitcnt lgkmcnt(0)
    ds_read_b64_tr_b16 v[112:113], v8 offset:0
    ds_read_b64_tr_b16 v[114:115], v8 offset:1024
    ds_read_b64_tr_b16 v[116:117], v9 offset:0
    ds_read_b64_tr_b16 v[118:119], v9 offset:1024
    ds_read_b64_tr_b16 v[120:121], v8 offset:2048
    ds_read_b64_tr_b16 v[122:123], v8 offset:3072
    ds_read_b64_tr_b16 v[124:125], v9 offset:2048
    ds_read_b64_tr_b16 v[126:127], v9 offset:3072
    s_waitcnt lgkmcnt(4)
    v_mfma_f32_32x32x16_bf16 v[16:31], v[112:115], v[80:83], v[16:31]
    s_waitcnt vmcnt(4)
    s_add_u32 m0, s77, 57344
    s_mul_i32 s4, s74, 14
    s_add_u32 s4, s4, s0
    buffer_load_dwordx4 v12, s[28:31], s4 offen lds
    s_waitcnt vmcnt(4)
    buffer_load_dwordx4 v2, s[28:31], s4 offen offset:1024 lds
    v_mfma_f32_32x32x16_bf16 v[32:47], v[116:119], v[80:83], 0
    s_waitcnt vmcnt(4)
    s_add_u32 m0, s77, 59392
    s_mul_i32 s4, s74, 14
    s_add_u32 s4, s4, s0
    s_add_u32 s4, s4, 14336
    buffer_load_dwordx4 v12, s[28:31], s4 offen lds
    s_waitcnt vmcnt(4)
    buffer_load_dwordx4 v2, s[28:31], s4 offen offset:1024 lds
    v_mfma_f32_32x32x16_bf16 v[48:63], v[112:115], v[84:87], 0
    s_waitcnt vmcnt(4)
    s_add_u32 m0, s77, 49152
    s_mul_i32 s4, s74, 14
    s_add_u32 s4, s4, s0
    s_add_u32 s4, s4, 28672
    buffer_load_dwordx4 v12, s[28:31], s4 offen lds
    s_waitcnt vmcnt(4)
    buffer_load_dwordx4 v2, s[28:31], s4 offen offset:1024 lds
    v_mfma_f32_32x32x16_bf16 v[64:79], v[116:119], v[84:87], 0
    s_waitcnt vmcnt(4)
    s_add_u32 m0, s77, 51200
    s_mul_i32 s4, s74, 14
    s_add_u32 s4, s4, s0
    s_add_u32 s4, s4, 43008
    buffer_load_dwordx4 v12, s[28:31], s4 offen lds
    ds_read_b64_tr_b16 v[208:209], v8 offset:57344
    ds_read_b64_tr_b16 v[210:211], v8 offset:58368
    ds_read_b64_tr_b16 v[212:213], v9 offset:57344
    ds_read_b64_tr_b16 v[214:215], v9 offset:58368
    s_waitcnt vmcnt(4)
    s_nop 0
    buffer_load_dwordx4 v2, s[28:31], s4 offen offset:1024 lds
    ds_read_b64_tr_b16 v[112:113], v8 offset:4096
    ds_read_b64_tr_b16 v[114:115], v8 offset:5120
    ds_read_b64_tr_b16 v[116:117], v9 offset:4096
    ds_read_b64_tr_b16 v[118:119], v9 offset:5120
    s_waitcnt lgkmcnt(8)
    v_mfma_f32_32x32x16_bf16 v[16:31], v[120:123], v[88:91], v[16:31]
    s_waitcnt vmcnt(4)
    buffer_load_dwordx4 v[80:83], v15, s[24:27], s71 offen offset:0 sc1
    ds_read_b64_tr_b16 v[216:217], v8 offset:59392
    ds_read_b64_tr_b16 v[218:219], v8 offset:60416
    ds_read_b64_tr_b16 v[220:221], v9 offset:59392
    ds_read_b64_tr_b16 v[222:223], v9 offset:60416
    s_waitcnt vmcnt(4)
    buffer_load_dwordx4 v[84:87], v11, s[24:27], s71 offen offset:0 sc1
    v_mfma_f32_32x32x16_bf16 v[32:47], v[124:127], v[88:91], v[32:47]
    s_waitcnt vmcnt(4)
    s_add_u32 m0, s77, 53248
    s_mul_i32 s4, s75, 14
    s_add_u32 s4, s4, s0
    buffer_load_dwordx4 v12, s[28:31], s4 offen lds
    s_waitcnt lgkmcnt(0)
    ds_read_b64_tr_b16 v[224:225], v8 offset:49152
    ds_read_b64_tr_b16 v[226:227], v8 offset:50176
    ds_read_b64_tr_b16 v[228:229], v9 offset:49152
    ds_read_b64_tr_b16 v[230:231], v9 offset:50176
    s_waitcnt vmcnt(4)
    buffer_load_dwordx4 v2, s[28:31], s4 offen offset:1024 lds
    v_mfma_f32_32x32x16_bf16 v[48:63], v[120:123], v[92:95], v[48:63]
    s_waitcnt vmcnt(4)
    s_add_u32 m0, s77, 55296
    s_mul_i32 s4, s75, 14
    s_add_u32 s4, s4, s0
    s_nop 0
    s_add_u32 s4, s4, 14336
    buffer_load_dwordx4 v12, s[28:31], s4 offen lds
    ds_read_b64_tr_b16 v[232:233], v8 offset:51200
    ds_read_b64_tr_b16 v[234:235], v8 offset:52224
    ds_read_b64_tr_b16 v[236:237], v9 offset:51200
    ds_read_b64_tr_b16 v[238:239], v9 offset:52224
    s_waitcnt vmcnt(4)
    buffer_load_dwordx4 v2, s[28:31], s4 offen offset:1024 lds
    v_mfma_f32_32x32x16_bf16 v[64:79], v[124:127], v[92:95], v[64:79]
    s_waitcnt vmcnt(4)
    s_add_u32 m0, s77, 57344
    s_mul_i32 s4, s75, 14
    s_add_u32 s4, s4, s0
    s_add_u32 s4, s4, 28672
    buffer_load_dwordx4 v12, s[28:31], s4 offen lds
    s_waitcnt vmcnt(4)
    s_nop 0
    buffer_load_dwordx4 v2, s[28:31], s4 offen offset:1024 lds
    ds_read_b64_tr_b16 v[120:121], v8 offset:6144
    ds_read_b64_tr_b16 v[122:123], v8 offset:7168
    ds_read_b64_tr_b16 v[124:125], v9 offset:6144
    ds_read_b64_tr_b16 v[126:127], v9 offset:7168
    v_mfma_f32_32x32x16_bf16 v[16:31], v[112:115], v[96:99], v[16:31]
    s_waitcnt vmcnt(4)
    buffer_load_dwordx4 v[88:91], v15, s[24:27], s71 offen offset:1024 sc1
    s_waitcnt lgkmcnt(0)
    ds_read_b64_tr_b16 v[240:241], v8 offset:53248
    ds_read_b64_tr_b16 v[242:243], v8 offset:54272
    ds_read_b64_tr_b16 v[244:245], v9 offset:53248
    ds_read_b64_tr_b16 v[246:247], v9 offset:54272
    s_waitcnt vmcnt(4)
    buffer_load_dwordx4 v[92:95], v11, s[24:27], s71 offen offset:1024 sc1
    v_mfma_f32_32x32x16_bf16 v[32:47], v[116:119], v[96:99], v[32:47]
    s_waitcnt vmcnt(4)
    s_add_u32 m0, s77, 59392
    s_mul_i32 s4, s75, 14
    s_add_u32 s4, s4, s0
    s_add_u32 s4, s4, 43008
    buffer_load_dwordx4 v12, s[28:31], s4 offen lds
    ds_read_b64_tr_b16 v[248:249], v8 offset:55296
    ds_read_b64_tr_b16 v[250:251], v8 offset:56320
    ds_read_b64_tr_b16 v[252:253], v9 offset:55296
    ds_read_b64_tr_b16 v[254:255], v9 offset:56320
    s_waitcnt vmcnt(4)
    buffer_load_dwordx4 v2, s[28:31], s4 offen offset:1024 lds
    v_mfma_f32_32x32x16_bf16 v[48:63], v[112:115], v[100:103], v[48:63]
    s_waitcnt vmcnt(4)
    s_add_u32 m0, s77, 49152
    s_mul_i32 s4, s76, 14
    s_add_u32 s4, s4, s0
    buffer_load_dwordx4 v12, s[28:31], s4 offen lds
    s_waitcnt vmcnt(4)
    buffer_load_dwordx4 v2, s[28:31], s4 offen offset:1024 lds
    v_mfma_f32_32x32x16_bf16 v[64:79], v[116:119], v[100:103], v[64:79]
    s_waitcnt vmcnt(4)
    s_add_u32 m0, s77, 51200
    s_mul_i32 s4, s76, 14
    s_add_u32 s4, s4, s0
    s_add_u32 s4, s4, 14336
    buffer_load_dwordx4 v12, s[28:31], s4 offen lds
    s_waitcnt vmcnt(4)
    s_nop 0
    buffer_load_dwordx4 v2, s[28:31], s4 offen offset:1024 lds
    ds_read_b64_tr_b16 v[112:113], v8 offset:8192
    ds_read_b64_tr_b16 v[114:115], v8 offset:9216
    ds_read_b64_tr_b16 v[116:117], v9 offset:8192
    ds_read_b64_tr_b16 v[118:119], v9 offset:9216
    v_mfma_f32_32x32x16_bf16 v[16:31], v[120:123], v[104:107], v[16:31]
    s_waitcnt vmcnt(4)
    buffer_load_dwordx4 v[96:99], v15, s[24:27], s71 offen offset:2048 sc1
    s_waitcnt vmcnt(4)
    buffer_load_dwordx4 v[100:103], v11, s[24:27], s71 offen offset:2048 sc1
    v_mfma_f32_32x32x16_bf16 v[32:47], v[124:127], v[104:107], v[32:47]
    s_waitcnt lgkmcnt(8)
    s_waitcnt vmcnt(4)
    s_add_u32 m0, s77, 53248
    s_mul_i32 s4, s76, 14
    s_add_u32 s4, s4, s0
    s_add_u32 s4, s4, 28672
    buffer_load_dwordx4 v12, s[28:31], s4 offen lds
    s_waitcnt vmcnt(4)
    buffer_load_dwordx4 v2, s[28:31], s4 offen offset:1024 lds
    v_mfma_f32_32x32x16_bf16 v[48:63], v[120:123], v[108:111], v[48:63]
    s_waitcnt lgkmcnt(4)
    s_waitcnt vmcnt(4)
    s_add_u32 m0, s77, 55296
    s_mul_i32 s4, s76, 14
    s_add_u32 s4, s4, s0
    s_add_u32 s4, s4, 43008
    buffer_load_dwordx4 v12, s[28:31], s4 offen lds
    s_waitcnt vmcnt(4)
    buffer_load_dwordx4 v2, s[28:31], s4 offen offset:1024 lds
    v_mfma_f32_32x32x16_bf16 v[64:79], v[124:127], v[108:111], v[64:79]
    s_waitcnt vmcnt(4)
    s_add_u32 m0, s7, 106496
    s_add_u32 s5, s6, 0
    buffer_load_dwordx4 v12, s[12:15], s5 offen lds
    s_waitcnt vmcnt(4)
    s_nop 0
    s_add_u32 m0, s7, 107520
    s_add_u32 s5, s6, 7168
    buffer_load_dwordx4 v12, s[12:15], s5 offen lds
    ds_read_b64_tr_b16 v[120:121], v8 offset:10240
    ds_read_b64_tr_b16 v[122:123], v8 offset:11264
    ds_read_b64_tr_b16 v[124:125], v9 offset:10240
    ds_read_b64_tr_b16 v[126:127], v9 offset:11264
    s_waitcnt lgkmcnt(4)
    v_mfma_f32_32x32x16_bf16 v[16:31], v[112:115], v[80:83], v[16:31]
    s_waitcnt vmcnt(4)
    buffer_load_dwordx4 v[104:107], v15, s[24:27], s71 offen offset:3072 sc1
    s_waitcnt vmcnt(4)
    buffer_load_dwordx4 v[108:111], v11, s[24:27], s71 offen offset:3072 sc1
    v_mfma_f32_32x32x16_bf16 v[32:47], v[116:119], v[80:83], v[32:47]
    s_waitcnt vmcnt(4)
    s_add_u32 m0, s7, 108544
    s_add_u32 s5, s6, 14336
    buffer_load_dwordx4 v12, s[12:15], s5 offen lds
    s_waitcnt vmcnt(4)
    s_add_u32 m0, s7, 109568
    s_add_u32 s5, s6, 21504
    buffer_load_dwordx4 v12, s[12:15], s5 offen lds
    v_mfma_f32_32x32x16_bf16 v[48:63], v[112:115], v[84:87], v[48:63]
    s_waitcnt vmcnt(4)
    s_add_u32 m0, s7, 110592
    s_add_u32 s5, s6, 28672
    buffer_load_dwordx4 v12, s[12:15], s5 offen lds
    s_waitcnt vmcnt(4)
    s_add_u32 m0, s7, 111616
    s_add_u32 s5, s6, 35840
    buffer_load_dwordx4 v12, s[12:15], s5 offen lds
    v_mfma_f32_32x32x16_bf16 v[64:79], v[116:119], v[84:87], v[64:79]
    s_waitcnt vmcnt(4)
    s_add_u32 m0, s7, 112640
    s_add_u32 s5, s6, 43008
    buffer_load_dwordx4 v12, s[12:15], s5 offen lds
    s_waitcnt vmcnt(4)
    s_add_u32 m0, s7, 113664
    s_add_u32 s5, s6, 50176
    buffer_load_dwordx4 v12, s[12:15], s5 offen lds
    s_waitcnt lgkmcnt(0)
    s_mov_b64 exec, 1
    ds_add_u32 v3, v4 offset:100
    s_mov_b64 exec, -1
    v_mfma_f32_32x32x16_bf16 v[16:31], v[120:123], v[88:91], v[16:31]
    s_waitcnt vmcnt(4)
    buffer_load_dwordx4 v[80:83], v15, s[24:27], s72 offen offset:0 sc1
    s_waitcnt vmcnt(4)
    buffer_load_dwordx4 v[84:87], v11, s[24:27], s72 offen offset:0 sc1
    v_mfma_f32_32x32x16_bf16 v[32:47], v[124:127], v[88:91], v[32:47]
    s_waitcnt vmcnt(4)
    s_add_u32 m0, s7, 114688
    s_add_u32 s5, s6, 57344
    buffer_load_dwordx4 v12, s[12:15], s5 offen lds
    s_waitcnt vmcnt(4)
    s_add_u32 m0, s7, 115712
    s_add_u32 s5, s6, 64512
    buffer_load_dwordx4 v12, s[12:15], s5 offen lds
    v_mfma_f32_32x32x16_bf16 v[48:63], v[120:123], v[92:95], v[48:63]
    s_waitcnt vmcnt(4)
    s_add_u32 m0, s7, 116736
    s_add_u32 s5, s6, 71680
    buffer_load_dwordx4 v12, s[12:15], s5 offen lds
    s_waitcnt vmcnt(4)
    s_add_u32 m0, s7, 117760
    s_add_u32 s5, s6, 78848
    buffer_load_dwordx4 v12, s[12:15], s5 offen lds
    v_mfma_f32_32x32x16_bf16 v[64:79], v[124:127], v[92:95], v[64:79]
    s_waitcnt vmcnt(4)
    s_add_u32 m0, s7, 118784
    s_add_u32 s5, s6, 86016
    buffer_load_dwordx4 v12, s[12:15], s5 offen lds
    s_waitcnt vmcnt(4)
    s_add_u32 m0, s7, 119808
    s_add_u32 s5, s6, 93184
    buffer_load_dwordx4 v12, s[12:15], s5 offen lds
    v_mfma_f32_32x32x16_bf16 v[16:31], v[128:131], v[96:99], v[16:31]
    s_waitcnt vmcnt(4)
    buffer_load_dwordx4 v[88:91], v15, s[24:27], s72 offen offset:1024 sc1
    s_waitcnt vmcnt(4)
    buffer_load_dwordx4 v[92:95], v11, s[24:27], s72 offen offset:1024 sc1
    v_mfma_f32_32x32x16_bf16 v[32:47], v[132:135], v[96:99], v[32:47]
    s_waitcnt vmcnt(4)
    buffer_load_dwordx4 v[112:115], v15, s[24:27], s72 offen offset:2048 sc1
    s_waitcnt vmcnt(4)
    buffer_load_dwordx4 v[116:119], v11, s[24:27], s72 offen offset:2048 sc1
    v_mfma_f32_32x32x16_bf16 v[48:63], v[128:131], v[100:103], v[48:63]
    s_waitcnt vmcnt(4)
    buffer_load_dwordx4 v[120:123], v15, s[24:27], s72 offen offset:3072 sc1
    s_waitcnt vmcnt(4)
    buffer_load_dwordx4 v[124:127], v11, s[24:27], s72 offen offset:3072 sc1
    v_mfma_f32_32x32x16_bf16 v[64:79], v[132:135], v[100:103], v[64:79]
    v_mfma_f32_32x32x16_bf16 v[16:31], v[136:139], v[104:107], v[16:31]
    s_waitcnt vmcnt(4)
    buffer_load_dwordx4 v[96:99], v15, s[24:27], s73 offen offset:0 sc1
    s_waitcnt vmcnt(4)
    buffer_load_dwordx4 v[100:103], v11, s[24:27], s73 offen offset:0 sc1
    v_mfma_f32_32x32x16_bf16 v[32:47], v[140:143], v[104:107], v[32:47]
    s_waitcnt vmcnt(4)
    buffer_load_dwordx4 v[128:131], v15, s[24:27], s73 offen offset:1024 sc1
    s_waitcnt vmcnt(4)
    buffer_load_dwordx4 v[132:135], v11, s[24:27], s73 offen offset:1024 sc1
    v_mfma_f32_32x32x16_bf16 v[48:63], v[136:139], v[108:111], v[48:63]
    v_mfma_f32_32x32x16_bf16 v[64:79], v[140:143], v[108:111], v[64:79]
    v_mfma_f32_32x32x16_bf16 v[16:31], v[144:147], v[80:83], v[16:31]
    s_waitcnt vmcnt(4)
    buffer_load_dwordx4 v[104:107], v15, s[24:27], s73 offen offset:2048 sc1
    s_waitcnt vmcnt(4)
    buffer_load_dwordx4 v[108:111], v11, s[24:27], s73 offen offset:2048 sc1
    v_mfma_f32_32x32x16_bf16 v[32:47], v[148:151], v[80:83], v[32:47]
    s_waitcnt vmcnt(4)
    buffer_load_dwordx4 v[136:139], v15, s[24:27], s73 offen offset:3072 sc1
    s_waitcnt vmcnt(4)
    buffer_load_dwordx4 v[140:143], v11, s[24:27], s73 offen offset:3072 sc1
    v_mfma_f32_32x32x16_bf16 v[48:63], v[144:147], v[84:87], v[48:63]
    v_mfma_f32_32x32x16_bf16 v[64:79], v[148:151], v[84:87], v[64:79]
    v_mfma_f32_32x32x16_bf16 v[16:31], v[152:155], v[88:91], v[16:31]
    s_waitcnt vmcnt(4)
    buffer_load_dwordx4 v[80:83], v15, s[24:27], s74 offen offset:0 sc1
    s_waitcnt vmcnt(4)
    buffer_load_dwordx4 v[84:87], v11, s[24:27], s74 offen offset:0 sc1
    v_mfma_f32_32x32x16_bf16 v[32:47], v[156:159], v[88:91], v[32:47]
    s_waitcnt vmcnt(4)
    buffer_load_dwordx4 v[144:147], v15, s[24:27], s74 offen offset:1024 sc1
    s_waitcnt vmcnt(4)
    buffer_load_dwordx4 v[148:151], v11, s[24:27], s74 offen offset:1024 sc1
    v_mfma_f32_32x32x16_bf16 v[48:63], v[152:155], v[92:95], v[48:63]
    v_mfma_f32_32x32x16_bf16 v[64:79], v[156:159], v[92:95], v[64:79]
    v_mfma_f32_32x32x16_bf16 v[16:31], v[160:163], v[112:115], v[16:31]
    buffer_load_dwordx4 v[88:91], v15, s[24:27], s74 offen offset:2048 sc1
    v_mfma_f32_32x32x16_bf16 v[32:47], v[164:167], v[112:115], v[32:47]
    buffer_load_dwordx4 v[92:95], v11, s[24:27], s74 offen offset:2048 sc1
    v_mfma_f32_32x32x16_bf16 v[48:63], v[160:163], v[116:119], v[48:63]
    buffer_load_dwordx4 v[152:155], v15, s[24:27], s74 offen offset:3072 sc1
    v_mfma_f32_32x32x16_bf16 v[64:79], v[164:167], v[116:119], v[64:79]
    buffer_load_dwordx4 v[156:159], v11, s[24:27], s74 offen offset:3072 sc1
    v_mfma_f32_32x32x16_bf16 v[16:31], v[168:171], v[120:123], v[16:31]
    buffer_load_dwordx4 v[112:115], v15, s[24:27], s75 offen offset:0 sc1
    v_mfma_f32_32x32x16_bf16 v[32:47], v[172:175], v[120:123], v[32:47]
    buffer_load_dwordx4 v[116:119], v11, s[24:27], s75 offen offset:0 sc1
    v_mfma_f32_32x32x16_bf16 v[48:63], v[168:171], v[124:127], v[48:63]
    buffer_load_dwordx4 v[160:163], v15, s[24:27], s75 offen offset:1024 sc1
    v_mfma_f32_32x32x16_bf16 v[64:79], v[172:175], v[124:127], v[64:79]
    buffer_load_dwordx4 v[164:167], v11, s[24:27], s75 offen offset:1024 sc1
    v_mfma_f32_32x32x16_bf16 v[16:31], v[176:179], v[96:99], v[16:31]
    s_waitcnt vmcnt(12)
    buffer_load_dwordx4 v[120:123], v15, s[24:27], s75 offen offset:2048 sc1
    v_mfma_f32_32x32x16_bf16 v[32:47], v[180:183], v[96:99], v[32:47]
    s_waitcnt vmcnt(12)
    buffer_load_dwordx4 v[124:127], v11, s[24:27], s75 offen offset:2048 sc1
    v_mfma_f32_32x32x16_bf16 v[48:63], v[176:179], v[100:103], v[48:63]
    s_waitcnt vmcnt(12)
    buffer_load_dwordx4 v[168:171], v15, s[24:27], s75 offen offset:3072 sc1
    v_mfma_f32_32x32x16_bf16 v[64:79], v[180:183], v[100:103], v[64:79]
    s_waitcnt vmcnt(12)
    buffer_load_dwordx4 v[172:175], v11, s[24:27], s75 offen offset:3072 sc1
    v_mfma_f32_32x32x16_bf16 v[16:31], v[184:187], v[128:131], v[16:31]
    s_waitcnt vmcnt(12)
    buffer_load_dwordx4 v[96:99], v15, s[24:27], s76 offen offset:0 sc1
    v_mfma_f32_32x32x16_bf16 v[32:47], v[188:191], v[128:131], v[32:47]
    s_waitcnt vmcnt(12)
    buffer_load_dwordx4 v[100:103], v11, s[24:27], s76 offen offset:0 sc1
    v_mfma_f32_32x32x16_bf16 v[48:63], v[184:187], v[132:135], v[48:63]
    s_waitcnt vmcnt(12)
    buffer_load_dwordx4 v[176:179], v15, s[24:27], s76 offen offset:1024 sc1
    v_mfma_f32_32x32x16_bf16 v[64:79], v[188:191], v[132:135], v[64:79]
    s_waitcnt vmcnt(12)
    buffer_load_dwordx4 v[180:183], v11, s[24:27], s76 offen offset:1024 sc1
    v_mfma_f32_32x32x16_bf16 v[16:31], v[192:195], v[104:107], v[16:31]
    s_waitcnt vmcnt(12)
    buffer_load_dwordx4 v[128:131], v15, s[24:27], s76 offen offset:2048 sc1
    v_mfma_f32_32x32x16_bf16 v[32:47], v[196:199], v[104:107], v[32:47]
    s_waitcnt vmcnt(12)
    buffer_load_dwordx4 v[132:135], v11, s[24:27], s76 offen offset:2048 sc1
    v_mfma_f32_32x32x16_bf16 v[48:63], v[192:195], v[108:111], v[48:63]
    s_waitcnt vmcnt(12)
    buffer_load_dwordx4 v[184:187], v15, s[24:27], s76 offen offset:3072 sc1
    v_mfma_f32_32x32x16_bf16 v[64:79], v[196:199], v[108:111], v[64:79]
    s_waitcnt vmcnt(12)
    buffer_load_dwordx4 v[188:191], v11, s[24:27], s76 offen offset:3072 sc1
    v_mfma_f32_32x32x16_bf16 v[16:31], v[200:203], v[136:139], v[16:31]
    v_mfma_f32_32x32x16_bf16 v[32:47], v[204:207], v[136:139], v[32:47]
    v_mfma_f32_32x32x16_bf16 v[48:63], v[200:203], v[140:143], v[48:63]
    v_mfma_f32_32x32x16_bf16 v[64:79], v[204:207], v[140:143], v[64:79]
    v_mfma_f32_32x32x16_bf16 v[16:31], v[208:211], v[80:83], v[16:31]
    v_add_u32 v1, s77, v7
    s_xor_b32 s51, s44, 1
    v_mfma_f32_32x32x16_bf16 v[32:47], v[212:215], v[80:83], v[32:47]
    s_mul_i32 s51, s51, 12288
    v_add_u32_e64 v12, s51, v7
    v_mfma_f32_32x32x16_bf16 v[48:63], v[208:211], v[84:87], v[48:63]
    s_xor_b32 s51, s44, 2
    s_mul_i32 s51, s51, 12288
    v_mfma_f32_32x32x16_bf16 v[64:79], v[212:215], v[84:87], v[64:79]
    v_add_u32 v2, s51, v7
    s_xor_b32 s51, s44, 3
    v_mfma_f32_32x32x16_bf16 v[16:31], v[216:219], v[144:147], v[16:31]
    s_mul_i32 s51, s51, 12288
    v_add_u32 v11, s51, v7
    v_mfma_f32_32x32x16_bf16 v[32:47], v[220:223], v[144:147], v[32:47]
    s_lshl_b32 s51, s41, 2
    v_add_u32 v15, s51, v3
    v_mfma_f32_32x32x16_bf16 v[48:63], v[216:219], v[148:151], v[48:63]
    s_mov_b32 s12, s22
    s_mov_b32 s13, s23
    v_mfma_f32_32x32x16_bf16 v[64:79], v[220:223], v[148:151], v[64:79]
    v_mfma_f32_32x32x16_bf16 v[16:31], v[224:227], v[88:91], v[16:31]
    v_mfma_f32_32x32x16_bf16 v[32:47], v[228:231], v[88:91], v[32:47]
    v_mfma_f32_32x32x16_bf16 v[48:63], v[224:227], v[92:95], v[48:63]
    v_mfma_f32_32x32x16_bf16 v[64:79], v[228:231], v[92:95], v[64:79]
    buffer_load_dword v5, v10, s[24:27], s68 offen sc1
    v_mfma_f32_32x32x16_bf16 v[16:31], v[232:235], v[152:155], v[16:31]
    ds_read_b64_tr_b16 v[104:105], v8 offset:57344
    ds_read_b64_tr_b16 v[106:107], v8 offset:58368
    ds_read_b64_tr_b16 v[108:109], v9 offset:57344
    ds_read_b64_tr_b16 v[110:111], v9 offset:58368
    v_mfma_f32_32x32x16_bf16 v[32:47], v[236:239], v[152:155], v[32:47]
    v_mfma_f32_32x32x16_bf16 v[48:63], v[232:235], v[156:159], v[48:63]
    ds_read_b64_tr_b16 v[192:193], v8 offset:59392
    ds_read_b64_tr_b16 v[194:195], v8 offset:60416
    ds_read_b64_tr_b16 v[196:197], v9 offset:59392
    ds_read_b64_tr_b16 v[198:199], v9 offset:60416
    v_mfma_f32_32x32x16_bf16 v[64:79], v[236:239], v[156:159], v[64:79]
    v_mfma_f32_32x32x16_bf16 v[16:31], v[240:243], v[112:115], v[16:31]
    s_waitcnt lgkmcnt(4)
    s_nop 0
    ds_read_b64_tr_b16 v[136:137], v8 offset:49152
    ds_read_b64_tr_b16 v[138:139], v8 offset:50176
    ds_read_b64_tr_b16 v[140:141], v9 offset:49152
    ds_read_b64_tr_b16 v[142:143], v9 offset:50176
    v_mfma_f32_32x32x16_bf16 v[32:47], v[244:247], v[112:115], v[32:47]
    v_mfma_f32_32x32x16_bf16 v[48:63], v[240:243], v[116:119], v[48:63]
    ds_read_b64_tr_b16 v[200:201], v8 offset:51200
    ds_read_b64_tr_b16 v[202:203], v8 offset:52224
    ds_read_b64_tr_b16 v[204:205], v9 offset:51200
    ds_read_b64_tr_b16 v[206:207], v9 offset:52224
    v_mfma_f32_32x32x16_bf16 v[64:79], v[244:247], v[116:119], v[64:79]
    s_waitcnt vmcnt(13)
    v_mfma_f32_32x32x16_bf16 v[16:31], v[248:251], v[160:163], v[16:31]
    s_waitcnt lgkmcnt(4)
    ds_read_b64_tr_b16 v[80:81], v8 offset:53248
    ds_read_b64_tr_b16 v[82:83], v8 offset:54272
    ds_read_b64_tr_b16 v[84:85], v9 offset:53248
    ds_read_b64_tr_b16 v[86:87], v9 offset:54272
    v_mfma_f32_32x32x16_bf16 v[32:47], v[252:255], v[160:163], v[32:47]
    s_waitcnt vmcnt(0)
    v_cmp_gt_u32 s[56:57], 1, v5
    s_mov_b64 exec, 1
    ds_add_u32 v3, v4 offset:64
    s_mov_b64 exec, -1
    v_mfma_f32_32x32x16_bf16 v[48:63], v[248:251], v[164:167], v[48:63]
    s_waitcnt lgkmcnt(5)
    ds_read_b64_tr_b16 v[208:209], v8 offset:55296
    ds_read_b64_tr_b16 v[210:211], v8 offset:56320
    ds_read_b64_tr_b16 v[212:213], v9 offset:55296
    ds_read_b64_tr_b16 v[214:215], v9 offset:56320
    v_mfma_f32_32x32x16_bf16 v[64:79], v[252:255], v[164:167], v[64:79]
    s_and_b32 s56, s56, 0x33
    s_cselect_b32 s14, 0, 16875520
    s_waitcnt lgkmcnt(0)
    v_mfma_f32_32x32x16_bf16 v[48:63], v[104:107], v[124:127], v[48:63]
    s_add_u32 s4, s69, 0
    s_nop 0
    buffer_load_dwordx4 v[144:147], v7, s[12:15], s4 offen offset:0 sc1
    v_mfma_f32_32x32x16_bf16 v[64:79], v[108:111], v[124:127], v[64:79]
    buffer_load_dwordx4 v[148:151], v7, s[12:15], s4 offen offset:1024 sc1
    v_mfma_f32_32x32x16_bf16 v[48:63], v[192:195], v[172:175], v[48:63]
    buffer_load_dwordx4 v[216:219], v7, s[12:15], s4 offen offset:2048 sc1
    v_mfma_f32_32x32x16_bf16 v[64:79], v[196:199], v[172:175], v[64:79]
    buffer_load_dwordx4 v[220:223], v7, s[12:15], s4 offen offset:3072 sc1
    v_mfma_f32_32x32x16_bf16 v[48:63], v[136:139], v[100:103], v[48:63]
    s_add_u32 s4, s69, 8192
    buffer_load_dwordx4 v[88:91], v7, s[12:15], s4 offen offset:0 sc1
    v_mfma_f32_32x32x16_bf16 v[64:79], v[140:143], v[100:103], v[64:79]
    buffer_load_dwordx4 v[92:95], v7, s[12:15], s4 offen offset:1024 sc1
    v_mfma_f32_32x32x16_bf16 v[48:63], v[200:203], v[180:183], v[48:63]
    buffer_load_dwordx4 v[224:227], v7, s[12:15], s4 offen offset:2048 sc1
    v_mfma_f32_32x32x16_bf16 v[64:79], v[204:207], v[180:183], v[64:79]
    buffer_load_dwordx4 v[228:231], v7, s[12:15], s4 offen offset:3072 sc1
    v_mfma_f32_32x32x16_bf16 v[48:63], v[80:83], v[132:135], v[48:63]
    ds_read_b32 v5, v3 offset:64
    v_and_b32 v8, 0xfffffdff, v13
    v_and_b32 v9, 0xfffffdff, v14
    v_mfma_f32_32x32x16_bf16 v[64:79], v[84:87], v[132:135], v[64:79]
    v_mfma_f32_32x32x16_bf16 v[48:63], v[208:211], v[188:191], v[48:63]
    s_waitcnt lgkmcnt(0)
    v_cmp_gt_u32 vcc, 4, v5
    v_mfma_f32_32x32x16_bf16 v[64:79], v[212:215], v[188:191], v[64:79]
    s_cbranch_vccnz L_wol
L_wol_x:
    s_nop 0
    v_mfma_f32_32x32x16_bf16 v[16:31], v[104:107], v[120:123], v[16:31]
    ds_read_b64_tr_b16 v[152:153], v14 offset:0
    ds_read_b64_tr_b16 v[154:155], v14 offset:1024
    ds_read_b64_tr_b16 v[156:157], v14 offset:2048
    ds_read_b64_tr_b16 v[158:159], v14 offset:3072
    v_mfma_f32_32x32x16_bf16 v[32:47], v[108:111], v[120:123], v[32:47]
    ds_read_b64_tr_b16 v[232:233], v14 offset:3584
    ds_read_b64_tr_b16 v[234:235], v14 offset:4608
    ds_read_b64_tr_b16 v[236:237], v14 offset:5632
    ds_read_b64_tr_b16 v[238:239], v14 offset:6656
    v_mfma_f32_32x32x16_bf16 v[16:31], v[192:195], v[168:171], v[16:31]
    ds_write_b128 v1, v[48:51] offset:53248
    v_mfma_f32_32x32x16_bf16 v[32:47], v[196:199], v[168:171], v[32:47]
    ds_write_b128 v1, v[52:55] offset:54272
    v_mfma_f32_32x32x16_bf16 v[16:31], v[136:139], v[96:99], v[16:31]
    ds_write_b128 v1, v[56:59] offset:55296
    v_mfma_f32_32x32x16_bf16 v[32:47], v[140:143], v[96:99], v[32:47]
    buffer_load_dword v248, v10, s[24:27], s68 offen sc1
    ds_write_b128 v1, v[60:63] offset:56320
    v_mfma_f32_32x32x16_bf16 v[16:31], v[200:203], v[176:179], v[16:31]
    ds_write_b128 v1, v[64:67] offset:57344
    s_waitcnt lgkmcnt(5)
    s_nop 0
    v_mfma_f32_32x32x16_bf16 v[32:47], v[204:207], v[176:179], v[32:47]
    ds_write_b128 v1, v[68:71] offset:58368
    v_mfma_f32_32x32x16_bf16 v[16:31], v[80:83], v[128:131], v[16:31]
    ds_write_b128 v1, v[72:75] offset:59392
    v_mfma_f32_32x32x16_bf16 v[32:47], v[84:87], v[128:131], v[32:47]
    ds_write_b128 v1, v[76:79] offset:60416
    v_mfma_f32_32x32x16_bf16 v[16:31], v[208:211], v[184:187], v[16:31]
    s_mov_b64 exec, 1
    ds_add_u32 v3, v4 offset:72
    s_mov_b64 exec, -1
    v_mfma_f32_32x32x16_bf16 v[32:47], v[212:215], v[184:187], v[32:47]
    ds_read_b64_tr_b16 v[112:113], v14 offset:14336
    ds_read_b64_tr_b16 v[114:115], v14 offset:15360
    ds_read_b64_tr_b16 v[116:117], v14 offset:16384
    ds_read_b64_tr_b16 v[118:119], v14 offset:17408
    s_cmp_lg_u32 s14, 0
    s_cbranch_scc1 L_have0
    s_mov_b32 s62, 0
L_p30:
    s_add_u32 s62, s62, 1
    s_waitcnt vmcnt(0)
    v_cmp_gt_u32 s[56:57], 1, v248
    s_cmp_gt_u32 s62, 65536
    s_cbranch_scc1 L_p30_x
    s_nop 1
    s_and_b32 s56, s56, 0x33
    s_cbranch_scc0 L_p30_x
    s_sleep 1
    buffer_load_dword v248, v10, s[24:27], s68 offen sc1
    s_branch L_p30
L_p30_x:
    s_add_u32 s4, s69, 0
    buffer_load_dwordx4 v[144:147], v7, s[24:27], s4 offen offset:0 sc1
    buffer_load_dwordx4 v[148:151], v7, s[24:27], s4 offen offset:1024 sc1
    buffer_load_dwordx4 v[216:219], v7, s[24:27], s4 offen offset:2048 sc1
    buffer_load_dwordx4 v[220:223], v7, s[24:27], s4 offen offset:3072 sc1
    s_add_u32 s4, s69, 8192
    buffer_load_dwordx4 v[88:91], v7, s[24:27], s4 offen offset:0 sc1
    buffer_load_dwordx4 v[92:95], v7, s[24:27], s4 offen offset:1024 sc1
    buffer_load_dwordx4 v[224:227], v7, s[24:27], s4 offen offset:2048 sc1
    buffer_load_dwordx4 v[228:231], v7, s[24:27], s4 offen offset:3072 sc1
    buffer_load_dword v248, v10, s[24:27], s68 offen sc1
L_have0:
    s_waitcnt vmcnt(8)
    v_mfma_f32_32x32x16_bf16 v[32:47], v[152:155], v[144:147], v[32:47]
    ds_read_b64_tr_b16 v[240:241], v14 offset:17920
    ds_read_b64_tr_b16 v[242:243], v14 offset:18944
    s_waitcnt vmcnt(7)
    v_mfma_f32_32x32x16_bf16 v[32:47], v[156:159], v[148:151], v[32:47]
    ds_read_b64_tr_b16 v[244:245], v14 offset:19968
    ds_read_b64_tr_b16 v[246:247], v14 offset:20992
    s_waitcnt vmcnt(6)
    v_mfma_f32_32x32x16_bf16 v[32:47], v[232:235], v[216:219], v[32:47]
    ds_read_b64_tr_b16 v[160:161], v13 offset:0
    ds_read_b64_tr_b16 v[162:163], v13 offset:1024
    s_waitcnt vmcnt(5)
    v_mfma_f32_32x32x16_bf16 v[32:47], v[236:239], v[220:223], v[32:47]
    ds_read_b64_tr_b16 v[164:165], v13 offset:2048
    ds_read_b64_tr_b16 v[166:167], v13 offset:3072
    ds_read_b32 v5, v3 offset:72
    s_waitcnt vmcnt(4) lgkmcnt(9)
    v_mfma_f32_32x32x16_bf16 v[32:47], v[112:115], v[88:91], v[32:47]
    ds_read_b64_tr_b16 v[152:153], v13 offset:3584
    ds_read_b64_tr_b16 v[154:155], v13 offset:4608
    s_waitcnt vmcnt(0)
    v_cmp_gt_u32 s[56:57], 1, v248
    v_mfma_f32_32x32x16_bf16 v[32:47], v[116:119], v[92:95], v[32:47]
    ds_read_b64_tr_b16 v[156:157], v13 offset:5632
    ds_read_b64_tr_b16 v[158:159], v13 offset:6656
    s_and_b32 s56, s56, 0xcc
    s_cselect_b32 s14, 0, 16875520
    s_add_u32 s4, s69, 4096
    buffer_load_dwordx4 v[120:123], v7, s[12:15], s4 offen offset:0 sc1
    s_waitcnt lgkmcnt(4)
    v_cmp_gt_u32 vcc, 4, v5
    v_mfma_f32_32x32x16_bf16 v[32:47], v[240:243], v[224:227], v[32:47]
    ds_read_b64_tr_b16 v[232:233], v13 offset:14336
    ds_read_b64_tr_b16 v[234:235], v13 offset:15360
    buffer_load_dwordx4 v[124:127], v7, s[12:15], s4 offen offset:1024 sc1
    s_cbranch_vccnz L_r1
L_r1_x:
    s_nop 0
    ds_read_b128 v[48:51], v2 offset:53248
    ds_read_b128 v[52:55], v2 offset:54272
    v_mfma_f32_32x32x16_bf16 v[32:47], v[244:247], v[228:231], v[32:47]
    ds_read_b64_tr_b16 v[236:237], v13 offset:16384
    ds_read_b64_tr_b16 v[238:239], v13 offset:17408
    buffer_load_dwordx4 v[104:107], v7, s[12:15], s4 offen offset:2048 sc1
    ds_read_b128 v[56:59], v2 offset:55296
    ds_read_b128 v[60:63], v2 offset:56320
    v_mfma_f32_32x32x16_bf16 v[16:31], v[160:163], v[144:147], v[16:31]
    ds_read_b64_tr_b16 v[112:113], v13 offset:17920
    ds_read_b64_tr_b16 v[114:115], v13 offset:18944
    buffer_load_dwordx4 v[108:111], v7, s[12:15], s4 offen offset:3072 sc1
    ds_read_b128 v[64:67], v11 offset:57344
    ds_read_b128 v[68:71], v11 offset:58368
    v_mfma_f32_32x32x16_bf16 v[16:31], v[164:167], v[148:151], v[16:31]
    ds_read_b64_tr_b16 v[116:117], v13 offset:19968
    ds_read_b64_tr_b16 v[118:119], v13 offset:20992
    s_add_u32 s4, s69, 12288
    buffer_load_dwordx4 v[168:171], v7, s[12:15], s4 offen offset:0 sc1
    ds_read_b128 v[72:75], v11 offset:59392
    ds_read_b128 v[76:79], v11 offset:60416
    s_waitcnt lgkmcnt(14)
    v_mfma_f32_32x32x16_bf16 v[16:31], v[152:155], v[216:219], v[16:31]
    ds_read_b64_tr_b16 v[240:241], v14 offset:7168
    ds_read_b64_tr_b16 v[242:243], v14 offset:8192
    buffer_load_dwordx4 v[172:175], v7, s[12:15], s4 offen offset:1024 sc1
    s_xor_b32 s51, s44, 2
    s_mul_i32 s51, s51, 12288
    s_add_u32 s51, s51, 4096
    v_and_b32_e64 v2, 31, v0
    v_mfma_f32_32x32x16_bf16 v[16:31], v[156:159], v[220:223], v[16:31]
    ds_read_b64_tr_b16 v[244:245], v14 offset:9216
    ds_read_b64_tr_b16 v[246:247], v14 offset:10240
    buffer_load_dwordx4 v[192:195], v7, s[12:15], s4 offen offset:2048 sc1
    v_mul_u32_u24 v2, 80, v2
    v_lshrrev_b32_e64 v5, 5, v0
    v_lshl_add_u32 v2, v5, 3, v2
    v_add_u32 v2, s51, v2
    s_waitcnt lgkmcnt(14)
    v_mfma_f32_32x32x16_bf16 v[16:31], v[232:235], v[88:91], v[16:31]
    ds_read_b64_tr_b16 v[160:161], v14 offset:10752
    ds_read_b64_tr_b16 v[162:163], v14 offset:11776
    buffer_load_dwordx4 v[196:199], v7, s[12:15], s4 offen offset:3072 sc1
    buffer_load_dword v248, v10, s[24:27], s68 offen sc1
    s_waitcnt lgkmcnt(6)
    v_add_f32 v48, v48, v64
    v_add_f32 v49, v49, v65
    v_add_f32 v50, v50, v66
    v_add_f32_e64 v51, v51, v67
    v_mfma_f32_32x32x16_bf16 v[16:31], v[236:239], v[92:95], v[16:31]
    ds_read_b64_tr_b16 v[164:165], v14 offset:12800
    ds_read_b64_tr_b16 v[166:167], v14 offset:13824
    v_add_f32 v52, v52, v68
    v_add_f32 v53, v53, v69
    v_add_f32 v54, v54, v70
    v_add_f32 v55, v55, v71
    v_mfma_f32_32x32x16_bf16 v[16:31], v[112:115], v[224:227], v[16:31]
    ds_read_b64_tr_b16 v[152:153], v14 offset:21504
    ds_read_b64_tr_b16 v[154:155], v14 offset:22528
    v_add_f32 v56, v56, v72
    v_add_f32 v57, v57, v73
    v_add_f32 v58, v58, v74
    v_add_f32 v59, v59, v75
    v_mfma_f32_32x32x16_bf16 v[16:31], v[116:119], v[228:231], v[16:31]
    ds_read_b64_tr_b16 v[156:157], v14 offset:23552
    ds_read_b64_tr_b16 v[158:159], v14 offset:24576
    v_add_f32 v60, v60, v76
    v_add_f32 v61, v61, v77
    v_add_f32_e64 v62, v62, v78
    v_add_f32 v63, v63, v79
    s_cmp_lg_u32 s14, 0
    s_cbranch_scc1 L_have1
    s_mov_b32 s62, 0
L_p31:
    s_add_u32 s62, s62, 1
    s_waitcnt vmcnt(0)
    v_cmp_gt_u32 s[56:57], 1, v248
    s_cmp_gt_u32 s62, 65536
    s_cbranch_scc1 L_p31_x
    s_nop 1
    s_and_b32 s56, s56, 0xcc
    s_cbranch_scc0 L_p31_x
    s_sleep 1
    buffer_load_dword v248, v10, s[24:27], s68 offen sc1
    s_branch L_p31
L_p31_x:
    s_nop 0
    s_add_u32 s4, s69, 4096
    buffer_load_dwordx4 v[120:123], v7, s[24:27], s4 offen offset:0 sc1
    buffer_load_dwordx4 v[124:127], v7, s[24:27], s4 offen offset:1024 sc1
    buffer_load_dwordx4 v[104:107], v7, s[24:27], s4 offen offset:2048 sc1
    buffer_load_dwordx4 v[108:111], v7, s[24:27], s4 offen offset:3072 sc1
    s_add_u32 s4, s69, 12288
    buffer_load_dwordx4 v[168:171], v7, s[24:27], s4 offen offset:0 sc1
    buffer_load_dwordx4 v[172:175], v7, s[24:27], s4 offen offset:1024 sc1
    buffer_load_dwordx4 v[192:195], v7, s[24:27], s4 offen offset:2048 sc1
    buffer_load_dwordx4 v[196:199], v7, s[24:27], s4 offen offset:3072 sc1
    buffer_load_dword v248, v10, s[24:27], s68 offen sc1
L_have1:
    s_waitcnt vmcnt(8) lgkmcnt(8)
    v_mfma_f32_32x32x16_bf16 v[32:47], v[240:243], v[120:123], v[32:47]
    ds_read_b64_tr_b16 v[232:233], v14 offset:25088
    ds_read_b64_tr_b16 v[234:235], v14 offset:26112
    v_lshrrev_b32 v5, 2, v0
    v_mul_u32_u24 v11, 80, v5
    v_and_b32_e64 v6, 3, v0
    v_lshl_add_u32 v11, v6, 4, v11
    s_waitcnt vmcnt(7)
    v_mfma_f32_32x32x16_bf16 v[32:47], v[244:247], v[124:127], v[32:47]
    ds_read_b64_tr_b16 v[236:237], v14 offset:27136
    ds_read_b64_tr_b16 v[238:239], v9 offset:28160
    v_add_u32 v11, s51, v11
    v_add_u32_e64 v5, s45, v5
    v_mul_u32_u24 v5, 896, v5
    v_lshl_add_u32 v5, v6, 4, v5
    s_waitcnt vmcnt(6) lgkmcnt(8)
    v_mfma_f32_32x32x16_bf16 v[32:47], v[160:163], v[104:107], v[32:47]
    ds_read_b64_tr_b16 v[112:113], v13 offset:7168
    ds_read_b64_tr_b16 v[114:115], v13 offset:8192
    v_add_u32 v6, s46, v5
    s_mov_b32 s51, 14336
    s_waitcnt vmcnt(5)
    v_mfma_f32_32x32x16_bf16 v[32:47], v[164:167], v[108:111], v[32:47]
    ds_read_b64_tr_b16 v[116:117], v13 offset:9216
    ds_read_b64_tr_b16 v[118:119], v13 offset:10240
    v_add_f32 v16, v16, v48
    v_add_f32 v17, v17, v49
    v_add_f32 v18, v18, v50
    v_add_f32 v19, v19, v51
    s_waitcnt vmcnt(4) lgkmcnt(8)
    v_mfma_f32_32x32x16_bf16 v[32:47], v[152:155], v[168:171], v[32:47]
    ds_read_b64_tr_b16 v[240:241], v13 offset:10752
    ds_read_b64_tr_b16 v[242:243], v13 offset:11776
    v_add_f32 v20, v20, v52
    v_add_f32 v21, v21, v53
    v_add_f32_e64 v22, v22, v54
    v_add_f32 v23, v23, v55
    s_waitcnt vmcnt(3)
    v_mfma_f32_32x32x16_bf16 v[32:47], v[156:159], v[172:175], v[32:47]
    ds_read_b64_tr_b16 v[244:245], v13 offset:12800
    ds_read_b64_tr_b16 v[246:247], v13 offset:13824
    v_add_f32 v24, v24, v56
    v_add_f32 v25, v25, v57
    v_add_f32_e64 v26, v26, v58
    v_add_f32 v27, v27, v59
    s_waitcnt vmcnt(2) lgkmcnt(8)
    v_mfma_f32_32x32x16_bf16 v[32:47], v[232:235], v[192:195], v[32:47]
    ds_read_b64_tr_b16 v[160:161], v13 offset:21504
    ds_read_b64_tr_b16 v[162:163], v13 offset:22528
    v_add_f32 v28, v28, v60
    v_add_f32 v29, v29, v61
    v_add_f32_e64 v30, v30, v62
    v_add_f32 v31, v31, v63
    s_waitcnt vmcnt(1)
    v_mfma_f32_32x32x16_bf16 v[32:47], v[236:239], v[196:199], v[32:47]
    ds_read_b64_tr_b16 v[164:165], v13 offset:23552
    ds_read_b64_tr_b16 v[166:167], v13 offset:24576
    s_waitcnt lgkmcnt(8)
    s_nop 0
    v_mfma_f32_32x32x16_bf16 v[16:31], v[112:115], v[120:123], v[16:31]
    ds_read_b64_tr_b16 v[152:153], v13 offset:25088
    ds_read_b64_tr_b16 v[154:155], v13 offset:26112
    v_mfma_f32_32x32x16_bf16 v[16:31], v[116:119], v[124:127], v[16:31]
    ds_read_b64_tr_b16 v[156:157], v13 offset:27136
    ds_read_b64_tr_b16 v[158:159], v8 offset:28160
    s_nop 7
    ds_write_b128 v1, v[32:35] offset:49152
    ds_write_b128 v1, v[36:39] offset:50176
    ds_write_b128 v1, v[40:43] offset:51200
    ds_write_b128 v1, v[44:47] offset:52224
    s_mov_b64 exec, 1
    ds_add_u32 v15, v4 offset:80
    s_mov_b64 exec, -1
    s_waitcnt lgkmcnt(13)
    v_mfma_f32_32x32x16_bf16 v[16:31], v[240:243], v[104:107], v[16:31]
    v_mfma_f32_32x32x16_bf16 v[16:31], v[244:247], v[108:111], v[16:31]
    s_waitcnt lgkmcnt(9)
    v_mfma_f32_32x32x16_bf16 v[16:31], v[160:163], v[168:171], v[16:31]
    v_mfma_f32_32x32x16_bf16 v[16:31], v[164:167], v[172:175], v[16:31]
    s_waitcnt lgkmcnt(5)
    v_mfma_f32_32x32x16_bf16 v[16:31], v[152:155], v[192:195], v[16:31]
    v_mfma_f32_32x32x16_bf16 v[16:31], v[156:159], v[196:199], v[16:31]
L_rx:
    ds_read_b32 v5, v15 offset:80
    s_waitcnt lgkmcnt(0)
    v_cmp_gt_u32 vcc, 2, v5
    s_nop 3
    s_cbranch_vccnz L_rx
    ds_read_b128 v[48:51], v12 offset:49152
    ds_read_b128 v[52:55], v12 offset:50176
    ds_read_b128 v[56:59], v12 offset:51200
    ds_read_b128 v[60:63], v12 offset:52224
    s_waitcnt lgkmcnt(2)
    v_add_f32 v16, v16, v48
    v_add_f32 v17, v17, v49
    v_add_f32 v18, v18, v50
    v_add_f32 v19, v19, v51
    v_add_f32 v20, v20, v52
    v_add_f32 v21, v21, v53
    v_add_f32 v22, v22, v54
    v_add_f32_e64 v23, v23, v55
    v_cvt_pk_bf16_f32 v64, v16, v17
    v_cvt_pk_bf16_f32 v65, v18, v19
    v_cvt_pk_bf16_f32 v66, v20, v21
    v_cvt_pk_bf16_f32 v67, v22, v23
    ds_write_b64 v2, v[64:65] offset:49152
    ds_write_b64 v2, v[66:67] offset:49168
    s_waitcnt lgkmcnt(0)
    v_add_f32 v24, v24, v56
    v_add_f32 v25, v25, v57
    v_add_f32 v26, v26, v58
    v_add_f32 v27, v27, v59
    v_add_f32 v28, v28, v60
    v_add_f32 v29, v29, v61
    v_add_f32 v30, v30, v62
    v_add_f32_e64 v31, v31, v63
    v_cvt_pk_bf16_f32 v68, v24, v25
    v_cvt_pk_bf16_f32 v69, v26, v27
    v_cvt_pk_bf16_f32 v70, v28, v29
    v_cvt_pk_bf16_f32 v71, v30, v31
    ds_write_b64 v2, v[68:69] offset:49184
    ds_write_b64 v2, v[70:71] offset:49200
    ds_read_b128 v[48:51], v11 offset:49152
    ds_read_b128 v[52:55], v11 offset:50432
    s_waitcnt lgkmcnt(1)
    buffer_store_dwordx4 v[48:51], v6, s[8:11], 0 offen
    s_waitcnt lgkmcnt(0)
    buffer_store_dwordx4 v[52:55], v6, s[8:11], s51 offen
L_h_end:
    s_endpgm
.p2align 3
L_pav:
    s_waitcnt lgkmcnt(8)
    s_nop 0
    v_mfma_f32_32x32x16_bf16 v[192:207], v[16:19], v[240:243], 0
    ds_read_b64_tr_b16 v[132:133], v168 offset:6200
    ds_read_b64_tr_b16 v[134:135], v168 offset:6968
    ds_read_b64_tr_b16 v[136:137], v168 offset:6256
    ds_read_b64_tr_b16 v[138:139], v168 offset:7024
    v_lshlrev_b32 v152, 16, v84
    v_and_b32 v153, s61, v84
    v_lshlrev_b32 v154, 16, v85
    v_and_b32 v155, s61, v85
    v_mfma_f32_32x32x16_bf16 v[208:223], v[16:19], v[244:247], 0
    ds_read_b64_tr_b16 v[140:141], v168 offset:9216
    ds_read_b64_tr_b16 v[142:143], v168 offset:9984
    v_lshlrev_b32 v156, 16, v86
    v_and_b32 v157, s61, v86
    v_lshlrev_b32 v158, 16, v87
    v_and_b32 v159, s61, v87
    v_mfma_f32_32x32x16_bf16 v[224:239], v[16:19], v[248:251], 0
    ds_read_b64_tr_b16 v[240:241], v168 offset:9272
    ds_read_b64_tr_b16 v[242:243], v168 offset:10040
    v_fma_f32 v152, v152, v148, v149
    v_fma_f32 v153, v153, v148, v149
    v_fma_f32 v154, v154, v148, v149
    v_fma_f32 v155, v155, v148, v149
    s_waitcnt lgkmcnt(10)
    s_nop 0
    v_mfma_f32_32x32x16_bf16 v[192:207], v[20:23], v[252:255], v[192:207]
    ds_read_b64_tr_b16 v[244:245], v168 offset:9328
    ds_read_b64_tr_b16 v[246:247], v168 offset:10096
    v_fma_f32 v156, v156, v148, v149
    v_fma_f32 v157, v157, v148, v149
    v_fma_f32 v158, v158, v148, v149
    v_fma_f32 v159, v159, v148, v149
    v_mfma_f32_32x32x16_bf16 v[208:223], v[20:23], v[8:11], v[208:223]
    ds_read_b64_tr_b16 v[248:249], v168 offset:12288
    ds_read_b64_tr_b16 v[250:251], v168 offset:13056
    v_cvt_pk_bf16_f32 v84, v152, v153
    v_cvt_pk_bf16_f32 v85, v154, v155
    v_cvt_pk_bf16_f32 v86, v156, v157
    v_mfma_f32_32x32x16_bf16 v[224:239], v[20:23], v[12:15], v[224:239]
    ds_read_b64_tr_b16 v[252:253], v168 offset:12344
    ds_read_b64_tr_b16 v[254:255], v168 offset:13112
    v_cvt_pk_bf16_f32 v87, v158, v159
    v_lshlrev_b32_e64 v152, 16, v88
    v_and_b32 v153, s61, v88
    s_waitcnt lgkmcnt(10)
    v_mfma_f32_32x32x16_bf16 v[192:207], v[24:27], v[128:131], v[192:207]
    ds_read_b64_tr_b16 v[8:9], v168 offset:12400
    ds_read_b64_tr_b16 v[10:11], v168 offset:13168
    v_lshlrev_b32 v154, 16, v89
    v_and_b32 v155, s61, v89
    v_lshlrev_b32_e64 v156, 16, v90
    v_mfma_f32_32x32x16_bf16 v[208:223], v[24:27], v[132:135], v[208:223]
    ds_read_b64_tr_b16 v[12:13], v168 offset:15360
    ds_read_b64_tr_b16 v[14:15], v168 offset:16128
    v_and_b32 v157, s61, v90
    v_lshlrev_b32 v158, 16, v91
    v_and_b32_e64 v159, s61, v91
    v_mfma_f32_32x32x16_bf16 v[224:239], v[24:27], v[136:139], v[224:239]
    ds_read_b64_tr_b16 v[128:129], v168 offset:15416
    ds_read_b64_tr_b16 v[130:131], v168 offset:16184
    v_fma_f32 v152, v152, v148, v149
    v_fma_f32 v153, v153, v148, v149
    v_fma_f32 v154, v154, v148, v149
    s_waitcnt lgkmcnt(10)
    s_nop 0
    v_mfma_f32_32x32x16_bf16 v[192:207], v[28:31], v[140:143], v[192:207]
    ds_read_b64_tr_b16 v[132:133], v168 offset:15472
    ds_read_b64_tr_b16 v[134:135], v168 offset:16240
    v_fma_f32 v155, v155, v148, v149
    v_fma_f32 v156, v156, v148, v149
    v_fma_f32 v157, v157, v148, v149
    v_mfma_f32_32x32x16_bf16 v[208:223], v[28:31], v[240:243], v[208:223]
    ds_read_b64_tr_b16 v[136:137], v168 offset:18432
    ds_read_b64_tr_b16 v[138:139], v168 offset:19200
    v_fma_f32 v158, v158, v148, v149
    v_fma_f32 v159, v159, v148, v149
    v_cvt_pk_bf16_f32 v88, v152, v153
    v_mfma_f32_32x32x16_bf16 v[224:239], v[28:31], v[244:247], v[224:239]
    ds_read_b64_tr_b16 v[140:141], v168 offset:18488
    ds_read_b64_tr_b16 v[142:143], v168 offset:19256
    v_cvt_pk_bf16_f32 v89, v154, v155
    v_cvt_pk_bf16_f32 v90, v156, v157
    v_cvt_pk_bf16_f32 v91, v158, v159
    s_waitcnt lgkmcnt(10)
    v_mfma_f32_32x32x16_bf16 v[192:207], v[32:35], v[248:251], v[192:207]
    ds_read_b64_tr_b16 v[240:241], v168 offset:18544
    ds_read_b64_tr_b16 v[242:243], v168 offset:19312
    v_lshlrev_b32 v152, 16, v92
    v_and_b32 v153, s61, v92
    v_lshlrev_b32 v154, 16, v93
    v_mfma_f32_32x32x16_bf16 v[208:223], v[32:35], v[252:255], v[208:223]
    ds_read_b64_tr_b16 v[244:245], v168 offset:21504
    ds_read_b64_tr_b16 v[246:247], v168 offset:22272
    v_and_b32 v155, s61, v93
    v_lshlrev_b32 v156, 16, v94
    v_and_b32_e64 v157, s61, v94
    v_mfma_f32_32x32x16_bf16 v[224:239], v[32:35], v[8:11], v[224:239]
    ds_read_b32 v5, v3 offset:56
    ds_read_b64_tr_b16 v[248:249], v168 offset:21560
    ds_read_b64_tr_b16 v[250:251], v168 offset:22328
    v_lshlrev_b32 v158, 16, v95
    v_and_b32 v159, s61, v95
    v_fma_f32 v152, v152, v148, v149
    s_waitcnt lgkmcnt(11)
    s_nop 0
    v_mfma_f32_32x32x16_bf16 v[192:207], v[36:39], v[12:15], v[192:207]
    ds_read_b64_tr_b16 v[252:253], v168 offset:21616
    ds_read_b64_tr_b16 v[254:255], v168 offset:22384
    v_fma_f32 v153, v153, v148, v149
    v_fma_f32 v154, v154, v148, v149
    v_fma_f32 v155, v155, v148, v149
    v_mfma_f32_32x32x16_bf16 v[208:223], v[36:39], v[128:131], v[208:223]
    s_waitcnt lgkmcnt(4)
    v_cmp_gt_u32 vcc, 4, v5
    v_fma_f32 v156, v156, v148, v149
    v_fma_f32 v157, v157, v148, v149
    v_fma_f32 v158, v158, v148, v149
    v_mfma_f32_32x32x16_bf16 v[224:239], v[36:39], v[132:135], v[224:239]
    s_cbranch_vccnz L_gq24v
L_gq24v_x:
    s_nop 0
    ds_read_b64_tr_b16 v[8:9], v168 offset:24576
    ds_read_b64_tr_b16 v[10:11], v168 offset:25344
    ds_read_b64_tr_b16 v[12:13], v168 offset:24632
    ds_read_b64_tr_b16 v[14:15], v168 offset:25400
    v_fma_f32 v159, v159, v148, v149
    v_cvt_pk_bf16_f32 v92, v152, v153
    v_cvt_pk_bf16_f32 v93, v154, v155
    v_mfma_f32_32x32x16_bf16 v[192:207], v[40:43], v[136:139], v[192:207]
    ds_read_b64_tr_b16 v[128:129], v168 offset:24688
    ds_read_b64_tr_b16 v[130:131], v168 offset:25456
    v_cvt_pk_bf16_f32 v94, v156, v157
    v_cvt_pk_bf16_f32 v95, v158, v159
    v_lshlrev_b32_e64 v152, 16, v96
    v_mfma_f32_32x32x16_bf16 v[208:223], v[40:43], v[140:143], v[208:223]
    ds_read_b64_tr_b16 v[132:133], v168 offset:27648
    ds_read_b64_tr_b16 v[134:135], v168 offset:28416
    v_and_b32 v153, s61, v96
    v_lshlrev_b32 v154, 16, v97
    v_and_b32_e64 v155, s61, v97
    v_mfma_f32_32x32x16_bf16 v[224:239], v[40:43], v[240:243], v[224:239]
    ds_read_b64_tr_b16 v[136:137], v168 offset:27704
    ds_read_b64_tr_b16 v[138:139], v168 offset:28472
    v_lshlrev_b32 v156, 16, v98
    v_and_b32 v157, s61, v98
    v_lshlrev_b32 v158, 16, v99
    s_waitcnt lgkmcnt(10)
    v_mfma_f32_32x32x16_bf16 v[192:207], v[44:47], v[244:247], v[192:207]
    ds_read_b64_tr_b16 v[140:141], v168 offset:27760
    ds_read_b64_tr_b16 v[142:143], v168 offset:28528
    v_and_b32_e64 v159, s61, v99
    v_fma_f32 v152, v152, v148, v149
    v_fma_f32 v153, v153, v148, v149
    v_mfma_f32_32x32x16_bf16 v[208:223], v[44:47], v[248:251], v[208:223]
    ds_read_b64_tr_b16 v[240:241], v168 offset:30720
    ds_read_b64_tr_b16 v[242:243], v168 offset:31488
    v_fma_f32 v154, v154, v148, v149
    v_fma_f32 v155, v155, v148, v149
    v_fma_f32 v156, v156, v148, v149
    v_mfma_f32_32x32x16_bf16 v[224:239], v[44:47], v[252:255], v[224:239]
    ds_read_b64_tr_b16 v[244:245], v168 offset:30776
    ds_read_b64_tr_b16 v[246:247], v168 offset:31544
    v_fma_f32 v157, v157, v148, v149
    v_fma_f32 v158, v158, v148, v149
    v_fma_f32 v159, v159, v148, v149
    s_waitcnt lgkmcnt(10)
    s_nop 0
    v_mfma_f32_32x32x16_bf16 v[192:207], v[48:51], v[8:11], v[192:207]
    ds_read_b64_tr_b16 v[248:249], v168 offset:30832
    ds_read_b64_tr_b16 v[250:251], v168 offset:31600
    v_cvt_pk_bf16_f32 v96, v152, v153
    v_cvt_pk_bf16_f32 v97, v154, v155
    v_cvt_pk_bf16_f32 v98, v156, v157
    v_mfma_f32_32x32x16_bf16 v[208:223], v[48:51], v[12:15], v[208:223]
    ds_read_b64_tr_b16 v[252:253], v168 offset:33792
    ds_read_b64_tr_b16 v[254:255], v168 offset:34560
    v_cvt_pk_bf16_f32 v99, v158, v159
    v_lshlrev_b32 v152, 16, v100
    v_and_b32 v153, s61, v100
    v_mfma_f32_32x32x16_bf16 v[224:239], v[48:51], v[128:131], v[224:239]
    ds_read_b64_tr_b16 v[8:9], v168 offset:33848
    ds_read_b64_tr_b16 v[10:11], v168 offset:34616
    v_lshlrev_b32 v154, 16, v101
    v_and_b32 v155, s61, v101
    v_lshlrev_b32 v156, 16, v102
    s_waitcnt lgkmcnt(10)
    v_mfma_f32_32x32x16_bf16 v[192:207], v[52:55], v[132:135], v[192:207]
    ds_read_b64_tr_b16 v[12:13], v168 offset:33904
    ds_read_b64_tr_b16 v[14:15], v168 offset:34672
    v_and_b32 v157, s61, v102
    v_lshlrev_b32 v158, 16, v103
    v_and_b32_e64 v159, s61, v103
    v_mfma_f32_32x32x16_bf16 v[208:223], v[52:55], v[136:139], v[208:223]
    ds_read_b64_tr_b16 v[128:129], v168 offset:36864
    ds_read_b64_tr_b16 v[130:131], v168 offset:37632
    v_fma_f32 v152, v152, v148, v149
    v_fma_f32 v153, v153, v148, v149
    v_fma_f32 v154, v154, v148, v149
    v_mfma_f32_32x32x16_bf16 v[224:239], v[52:55], v[140:143], v[224:239]
    ds_read_b64_tr_b16 v[132:133], v168 offset:36920
    ds_read_b64_tr_b16 v[134:135], v168 offset:37688
    v_fma_f32 v155, v155, v148, v149
    v_fma_f32 v156, v156, v148, v149
    v_fma_f32 v157, v157, v148, v149
    s_waitcnt lgkmcnt(10)
    s_nop 0
    v_mfma_f32_32x32x16_bf16 v[192:207], v[56:59], v[240:243], v[192:207]
    ds_read_b64_tr_b16 v[136:137], v168 offset:36976
    ds_read_b64_tr_b16 v[138:139], v168 offset:37744
    v_fma_f32 v158, v158, v148, v149
    v_fma_f32 v159, v159, v148, v149
    v_cvt_pk_bf16_f32 v100, v152, v153
    v_mfma_f32_32x32x16_bf16 v[208:223], v[56:59], v[244:247], v[208:223]
    ds_read_b64_tr_b16 v[140:141], v168 offset:39936
    ds_read_b64_tr_b16 v[142:143], v168 offset:40704
    v_cvt_pk_bf16_f32 v101, v154, v155
    v_cvt_pk_bf16_f32 v102, v156, v157
    v_cvt_pk_bf16_f32 v103, v158, v159
    v_mfma_f32_32x32x16_bf16 v[224:239], v[56:59], v[248:251], v[224:239]
    ds_read_b64_tr_b16 v[240:241], v168 offset:39992
    ds_read_b64_tr_b16 v[242:243], v168 offset:40760
    v_lshlrev_b32 v152, 16, v104
    v_and_b32 v153, s61, v104
    v_lshlrev_b32 v154, 16, v105
    s_waitcnt lgkmcnt(10)
    v_mfma_f32_32x32x16_bf16 v[192:207], v[60:63], v[252:255], v[192:207]
    s_mov_b64 exec, 1
    ds_add_u32 v3, v4 offset:88
    s_mov_b64 exec, -1
    ds_read_b64_tr_b16 v[244:245], v168 offset:40048
    ds_read_b64_tr_b16 v[246:247], v168 offset:40816
    v_and_b32 v155, s61, v105
    v_lshlrev_b32 v156, 16, v106
    v_and_b32_e64 v157, s61, v106
    v_mfma_f32_32x32x16_bf16 v[208:223], v[60:63], v[8:11], v[208:223]
    ds_read_b64_tr_b16 v[248:249], v168 offset:43008
    ds_read_b64_tr_b16 v[250:251], v168 offset:43776
    v_lshlrev_b32 v158, 16, v107
    v_and_b32 v159, s61, v107
    v_fma_f32 v152, v152, v148, v149
    v_mfma_f32_32x32x16_bf16 v[224:239], v[60:63], v[12:15], v[224:239]
    ds_read_b64_tr_b16 v[252:253], v168 offset:43064
    ds_read_b64_tr_b16 v[254:255], v168 offset:43832
    v_fma_f32 v153, v153, v148, v149
    v_fma_f32 v154, v154, v148, v149
    v_fma_f32 v155, v155, v148, v149
    s_waitcnt lgkmcnt(11)
    s_nop 0
    v_mfma_f32_32x32x16_bf16 v[192:207], v[64:67], v[128:131], v[192:207]
    ds_read_b64_tr_b16 v[8:9], v168 offset:43120
    ds_read_b64_tr_b16 v[10:11], v168 offset:43888
    v_fma_f32 v156, v156, v148, v149
    v_fma_f32 v157, v157, v148, v149
    v_fma_f32 v158, v158, v148, v149
    v_mfma_f32_32x32x16_bf16 v[208:223], v[64:67], v[132:135], v[208:223]
    ds_read_b64_tr_b16 v[12:13], v168 offset:46080
    ds_read_b64_tr_b16 v[14:15], v168 offset:46848
    v_fma_f32 v159, v159, v148, v149
    v_cvt_pk_bf16_f32 v104, v152, v153
    v_cvt_pk_bf16_f32 v105, v154, v155
    v_mfma_f32_32x32x16_bf16 v[224:239], v[64:67], v[136:139], v[224:239]
    ds_read_b32 v5, v3 offset:60
    ds_read_b64_tr_b16 v[128:129], v168 offset:46136
    ds_read_b64_tr_b16 v[130:131], v168 offset:46904
    v_cvt_pk_bf16_f32 v106, v156, v157
    v_cvt_pk_bf16_f32 v107, v158, v159
    v_lshlrev_b32 v152, 16, v108
    s_waitcnt lgkmcnt(11)
    v_mfma_f32_32x32x16_bf16 v[192:207], v[68:71], v[140:143], v[192:207]
    ds_read_b64_tr_b16 v[132:133], v168 offset:46192
    ds_read_b64_tr_b16 v[134:135], v168 offset:46960
    v_and_b32 v153, s61, v108
    v_lshlrev_b32 v154, 16, v109
    v_and_b32_e64 v155, s61, v109
    v_mfma_f32_32x32x16_bf16 v[208:223], v[68:71], v[240:243], v[208:223]
    s_waitcnt lgkmcnt(4)
    v_cmp_gt_u32 vcc, 4, v5
    v_lshlrev_b32 v156, 16, v110
    v_and_b32 v157, s61, v110
    v_lshlrev_b32_e64 v158, 16, v111
    v_mfma_f32_32x32x16_bf16 v[224:239], v[68:71], v[244:247], v[224:239]
    s_cbranch_vccnz L_gq48v
L_gq48v_x:
    ds_read_b64_tr_b16 v[136:137], v169 offset:0
    ds_read_b64_tr_b16 v[138:139], v169 offset:768
    ds_read_b64_tr_b16 v[140:141], v169 offset:56
    ds_read_b64_tr_b16 v[142:143], v169 offset:824
    v_and_b32 v159, s61, v111
    v_fma_f32 v152, v152, v148, v149
    v_fma_f32 v153, v153, v148, v149
    v_mfma_f32_32x32x16_bf16 v[192:207], v[72:75], v[248:251], v[192:207]
    ds_read_b64_tr_b16 v[240:241], v169 offset:112
    ds_read_b64_tr_b16 v[242:243], v169 offset:880
    v_fma_f32 v154, v154, v148, v149
    v_fma_f32 v155, v155, v148, v149
    v_fma_f32 v156, v156, v148, v149
    v_mfma_f32_32x32x16_bf16 v[208:223], v[72:75], v[252:255], v[208:223]
    ds_read_b64_tr_b16 v[244:245], v169 offset:28672
    ds_read_b64_tr_b16 v[246:247], v169 offset:29440
    v_fma_f32 v157, v157, v148, v149
    v_fma_f32 v158, v158, v148, v149
    v_fma_f32 v159, v159, v148, v149
    v_mfma_f32_32x32x16_bf16 v[224:239], v[72:75], v[8:11], v[224:239]
    ds_read_b64_tr_b16 v[248:249], v169 offset:28728
    ds_read_b64_tr_b16 v[250:251], v169 offset:29496
    v_cvt_pk_bf16_f32 v108, v152, v153
    v_cvt_pk_bf16_f32 v109, v154, v155
    v_cvt_pk_bf16_f32 v110, v156, v157
    s_waitcnt lgkmcnt(10)
    v_mfma_f32_32x32x16_bf16 v[192:207], v[76:79], v[12:15], v[192:207]
    ds_read_b64_tr_b16 v[252:253], v169 offset:28784
    ds_read_b64_tr_b16 v[254:255], v169 offset:29552
    v_cvt_pk_bf16_f32 v111, v158, v159
    v_lshlrev_b32 v152, 16, v112
    v_and_b32_e64 v153, s61, v112
    v_mfma_f32_32x32x16_bf16 v[208:223], v[76:79], v[128:131], v[208:223]
    ds_read_b64_tr_b16 v[8:9], v170 offset:0
    ds_read_b64_tr_b16 v[10:11], v170 offset:768
    v_lshlrev_b32 v154, 16, v113
    v_and_b32 v155, s61, v113
    v_lshlrev_b32_e64 v156, 16, v114
    v_mfma_f32_32x32x16_bf16 v[224:239], v[76:79], v[132:135], v[224:239]
    ds_read_b64_tr_b16 v[12:13], v170 offset:56
    ds_read_b64_tr_b16 v[14:15], v170 offset:824
    v_and_b32 v157, s61, v114
    v_lshlrev_b32 v158, 16, v115
    v_and_b32 v159, s61, v115
    s_waitcnt lgkmcnt(10)
    v_mfma_f32_32x32x16_bf16 v[192:207], v[80:83], v[136:139], v[192:207]
    ds_read_b64_tr_b16 v[128:129], v170 offset:112
    ds_read_b64_tr_b16 v[130:131], v170 offset:880
    v_fma_f32 v152, v152, v148, v149
    v_fma_f32 v153, v153, v148, v149
    v_fma_f32 v154, v154, v148, v149
    v_mfma_f32_32x32x16_bf16 v[208:223], v[80:83], v[140:143], v[208:223]
    ds_read_b64_tr_b16 v[132:133], v170 offset:28672
    ds_read_b64_tr_b16 v[134:135], v170 offset:29440
    v_fma_f32 v155, v155, v148, v149
    v_fma_f32 v156, v156, v148, v149
    v_fma_f32 v157, v157, v148, v149
    v_mfma_f32_32x32x16_bf16 v[224:239], v[80:83], v[240:243], v[224:239]
    ds_read_b32 v5, v3 offset:104
    ds_read_b64_tr_b16 v[136:137], v170 offset:28728
    ds_read_b64_tr_b16 v[138:139], v170 offset:29496
    v_fma_f32 v158, v158, v148, v149
    v_fma_f32 v159, v159, v148, v149
    v_cvt_pk_bf16_f32 v112, v152, v153
    s_waitcnt lgkmcnt(11)
    s_nop 0
    v_mfma_f32_32x32x16_bf16 v[192:207], v[84:87], v[244:247], v[192:207]
    ds_read_b64_tr_b16 v[140:141], v170 offset:28784
    ds_read_b64_tr_b16 v[142:143], v170 offset:29552
    v_cvt_pk_bf16_f32 v113, v154, v155
    v_cvt_pk_bf16_f32 v114, v156, v157
    v_cvt_pk_bf16_f32 v115, v158, v159
    v_mfma_f32_32x32x16_bf16 v[208:223], v[84:87], v[248:251], v[208:223]
    s_waitcnt lgkmcnt(4)
    v_cmp_gt_u32 vcc, 4, v5
    v_lshlrev_b32 v152, 16, v116
    v_and_b32 v153, s61, v116
    v_lshlrev_b32_e64 v154, 16, v117
    v_mfma_f32_32x32x16_bf16 v[224:239], v[84:87], v[252:255], v[224:239]
    s_cbranch_vccnz L_gq60v
L_gq60v_x:
    ds_read_b64_tr_b16 v[240:241], v169 offset:7168
    ds_read_b64_tr_b16 v[242:243], v169 offset:7936
    ds_read_b64_tr_b16 v[244:245], v169 offset:7224
    ds_read_b64_tr_b16 v[246:247], v169 offset:7992
    v_and_b32 v155, s61, v117
    v_lshlrev_b32 v156, 16, v118
    v_and_b32 v157, s61, v118
    v_mfma_f32_32x32x16_bf16 v[192:207], v[88:91], v[8:11], v[192:207]
    ds_read_b64_tr_b16 v[248:249], v169 offset:7280
    ds_read_b64_tr_b16 v[250:251], v169 offset:8048
    v_lshlrev_b32 v158, 16, v119
    v_and_b32 v159, s61, v119
    v_fma_f32 v152, v152, v148, v149
    v_mfma_f32_32x32x16_bf16 v[208:223], v[88:91], v[12:15], v[208:223]
    ds_read_b64_tr_b16 v[252:253], v169 offset:35840
    ds_read_b64_tr_b16 v[254:255], v169 offset:36608
    v_fma_f32 v153, v153, v148, v149
    v_fma_f32 v154, v154, v148, v149
    v_fma_f32 v155, v155, v148, v149
    v_mfma_f32_32x32x16_bf16 v[224:239], v[88:91], v[128:131], v[224:239]
    ds_read_b64_tr_b16 v[8:9], v169 offset:35896
    ds_read_b64_tr_b16 v[10:11], v169 offset:36664
    v_fma_f32 v156, v156, v148, v149
    v_fma_f32 v157, v157, v148, v149
    v_fma_f32 v158, v158, v148, v149
    s_waitcnt lgkmcnt(10)
    v_mfma_f32_32x32x16_bf16 v[192:207], v[92:95], v[132:135], v[192:207]
    s_mov_b64 exec, 1
    ds_add_u32 v3, v4 offset:92
    s_mov_b64 exec, -1
    s_nop 0
    ds_read_b64_tr_b16 v[12:13], v169 offset:35952
    ds_read_b64_tr_b16 v[14:15], v169 offset:36720
    v_fma_f32 v159, v159, v148, v149
    v_cvt_pk_bf16_f32 v116, v152, v153
    v_cvt_pk_bf16_f32 v117, v154, v155
    v_mfma_f32_32x32x16_bf16 v[208:223], v[92:95], v[136:139], v[208:223]
    ds_read_b64_tr_b16 v[128:129], v170 offset:7168
    ds_read_b64_tr_b16 v[130:131], v170 offset:7936
    v_cvt_pk_bf16_f32 v118, v156, v157
    v_cvt_pk_bf16_f32 v119, v158, v159
    v_lshlrev_b32_e64 v152, 16, v120
    v_mfma_f32_32x32x16_bf16 v[224:239], v[92:95], v[140:143], v[224:239]
    ds_read_b64_tr_b16 v[132:133], v170 offset:7224
    ds_read_b64_tr_b16 v[134:135], v170 offset:7992
    v_and_b32 v153, s61, v120
    v_lshlrev_b32 v154, 16, v121
    v_and_b32 v155, s61, v121
    s_waitcnt lgkmcnt(11)
    v_mfma_f32_32x32x16_bf16 v[192:207], v[96:99], v[240:243], v[192:207]
    ds_read_b64_tr_b16 v[136:137], v170 offset:7280
    ds_read_b64_tr_b16 v[138:139], v170 offset:8048
    v_lshlrev_b32 v156, 16, v122
    v_and_b32 v157, s61, v122
    v_lshlrev_b32_e64 v158, 16, v123
    v_mfma_f32_32x32x16_bf16 v[208:223], v[96:99], v[244:247], v[208:223]
    ds_read_b64_tr_b16 v[140:141], v170 offset:35840
    ds_read_b64_tr_b16 v[142:143], v170 offset:36608
    v_and_b32_e64 v159, s61, v123
    v_fma_f32 v152, v152, v148, v149
    v_fma_f32 v153, v153, v148, v149
    v_mfma_f32_32x32x16_bf16 v[224:239], v[96:99], v[248:251], v[224:239]
    ds_read_b32 v5, v3 offset:108
    ds_read_b64_tr_b16 v[240:241], v170 offset:35896
    ds_read_b64_tr_b16 v[242:243], v170 offset:36664
    v_fma_f32 v154, v154, v148, v149
    v_fma_f32 v155, v155, v148, v149
    v_fma_f32 v156, v156, v148, v149
    s_waitcnt lgkmcnt(11)
    s_nop 0
    v_mfma_f32_32x32x16_bf16 v[192:207], v[100:103], v[252:255], v[192:207]
    ds_read_b64_tr_b16 v[244:245], v170 offset:35952
    ds_read_b64_tr_b16 v[246:247], v170 offset:36720
    v_fma_f32 v157, v157, v148, v149
    v_fma_f32 v158, v158, v148, v149
    v_fma_f32 v159, v159, v148, v149
    v_mfma_f32_32x32x16_bf16 v[208:223], v[100:103], v[8:11], v[208:223]
    s_waitcnt lgkmcnt(4)
    v_cmp_gt_u32 vcc, 4, v5
    v_cvt_pk_bf16_f32 v120, v152, v153
    v_cvt_pk_bf16_f32 v121, v154, v155
    v_cvt_pk_bf16_f32 v122, v156, v157
    v_mfma_f32_32x32x16_bf16 v[224:239], v[100:103], v[12:15], v[224:239]
    s_cbranch_vccnz L_gq72v
L_gq72v_x:
    s_nop 0
    ds_read_b64_tr_b16 v[248:249], v169 offset:10240
    ds_read_b64_tr_b16 v[250:251], v169 offset:11008
    ds_read_b64_tr_b16 v[252:253], v169 offset:38912
    ds_read_b64_tr_b16 v[254:255], v169 offset:39680
    v_cvt_pk_bf16_f32 v123, v158, v159
    v_lshlrev_b32 v152, 16, v124
    v_and_b32 v153, s61, v124
    v_mfma_f32_32x32x16_bf16 v[192:207], v[104:107], v[128:131], v[192:207]
    ds_read_b64_tr_b16 v[8:9], v170 offset:10240
    ds_read_b64_tr_b16 v[10:11], v170 offset:11008
    v_lshlrev_b32 v154, 16, v125
    v_and_b32 v155, s61, v125
    v_lshlrev_b32_e64 v156, 16, v126
    v_mfma_f32_32x32x16_bf16 v[208:223], v[104:107], v[132:135], v[208:223]
    ds_read_b64_tr_b16 v[12:13], v170 offset:38912
    ds_read_b64_tr_b16 v[14:15], v170 offset:39680
    v_and_b32 v157, s61, v126
    v_lshlrev_b32 v158, 16, v127
    v_and_b32_e64 v159, s61, v127
    v_mfma_f32_32x32x16_bf16 v[224:239], v[104:107], v[136:139], v[224:239]
    ds_read_b64_tr_b16 v[128:129], v169 offset:10296
    ds_read_b64_tr_b16 v[130:131], v169 offset:11064
    v_fma_f32 v152, v152, v148, v149
    v_fma_f32 v153, v153, v148, v149
    v_fma_f32 v154, v154, v148, v149
    s_waitcnt lgkmcnt(10)
    s_nop 0
    v_mfma_f32_32x32x16_bf16 v[192:207], v[108:111], v[140:143], v[192:207]
    ds_read_b64_tr_b16 v[132:133], v169 offset:38968
    ds_read_b64_tr_b16 v[134:135], v169 offset:39736
    v_fma_f32 v155, v155, v148, v149
    v_fma_f32 v156, v156, v148, v149
    v_fma_f32 v157, v157, v148, v149
    v_mfma_f32_32x32x16_bf16 v[208:223], v[108:111], v[240:243], v[208:223]
    ds_read_b64_tr_b16 v[136:137], v170 offset:10296
    ds_read_b64_tr_b16 v[138:139], v170 offset:11064
    v_fma_f32 v158, v158, v148, v149
    v_fma_f32 v159, v159, v148, v149
    v_cvt_pk_bf16_f32 v124, v152, v153
    v_mfma_f32_32x32x16_bf16 v[224:239], v[108:111], v[244:247], v[224:239]
    ds_read_b64_tr_b16 v[140:141], v170 offset:38968
    ds_read_b64_tr_b16 v[142:143], v170 offset:39736
    v_cvt_pk_bf16_f32 v125, v154, v155
    v_cvt_pk_bf16_f32 v126, v156, v157
    v_cvt_pk_bf16_f32 v127, v158, v159
    s_waitcnt lgkmcnt(10)
    s_nop 0
    v_mfma_f32_32x32x16_bf16 v[192:207], v[112:115], v[248:251], v[192:207]
    ds_read_b64_tr_b16 v[240:241], v169 offset:10352
    ds_read_b64_tr_b16 v[242:243], v169 offset:11120
    v_mfma_f32_32x32x16_bf16 v[192:207], v[116:119], v[252:255], v[192:207]
    ds_read_b64_tr_b16 v[244:245], v169 offset:39024
    ds_read_b64_tr_b16 v[246:247], v169 offset:39792
    v_mfma_f32_32x32x16_bf16 v[192:207], v[120:123], v[8:11], v[192:207]
    ds_read_b32 v5, v3 offset:0
    ds_read_b64_tr_b16 v[248:249], v170 offset:10352
    ds_read_b64_tr_b16 v[250:251], v170 offset:11120
    s_waitcnt lgkmcnt(11)
    v_mfma_f32_32x32x16_bf16 v[192:207], v[124:127], v[12:15], v[192:207]
    ds_read_b64_tr_b16 v[252:253], v170 offset:39024
    ds_read_b64_tr_b16 v[254:255], v170 offset:39792
    v_mfma_f32_32x32x16_bf16 v[208:223], v[112:115], v[128:131], v[208:223]
    s_waitcnt lgkmcnt(4)
    v_cmp_gt_u32_e64 vcc, 4, v5
    v_mfma_f32_32x32x16_bf16 v[208:223], v[116:119], v[132:135], v[208:223]
    s_cbranch_vccnz L_gate0v
L_gate0v_x:
    s_nop 0
    ds_read_b64_tr_b16 v[8:9], v2 offset:14336
    ds_read_b64_tr_b16 v[10:11], v2 offset:15232
    ds_read_b64_tr_b16 v[12:13], v2 offset:14368
    ds_read_b64_tr_b16 v[14:15], v2 offset:15264
    v_mfma_f32_32x32x16_bf16 v[208:223], v[120:123], v[136:139], v[208:223]
    v_cvt_pk_bf16_f32 v192, v192, v193
    v_cvt_pk_bf16_f32 v193, v194, v195
    v_cvt_pk_bf16_f32 v194, v196, v197
    v_cvt_pk_bf16_f32 v195, v198, v199
    v_cvt_pk_bf16_f32 v196, v200, v201
    v_cvt_pk_bf16_f32 v197, v202, v203
    v_mfma_f32_32x32x16_bf16 v[208:223], v[124:127], v[140:143], v[208:223]
    v_cvt_pk_bf16_f32 v198, v204, v205
    v_cvt_pk_bf16_f32 v199, v206, v207
    v_cndmask_b32 v192, v6, v192, s[38:39]
    v_cndmask_b32 v193, v6, v193, s[38:39]
    v_cndmask_b32 v194, v6, v194, s[38:39]
    v_cndmask_b32 v195, v6, v195, s[38:39]
    v_mfma_f32_32x32x16_bf16 v[224:239], v[112:115], v[240:243], v[224:239]
    v_cndmask_b32 v196, v6, v196, s[38:39]
    v_cndmask_b32 v197, v6, v197, s[38:39]
    v_cndmask_b32 v198, v6, v198, s[38:39]
    v_cndmask_b32 v199, v6, v199, s[38:39]
    s_waitcnt lgkmcnt(4)
    s_nop 0
    v_mfma_f32_32x32x16_bf16 v[224:239], v[116:119], v[244:247], v[224:239]
    buffer_store_dwordx4 v[192:195], v7, s[24:27], s32 offen offset:0 sc1
    v_mfma_f32_32x32x16_bf16 v[224:239], v[120:123], v[248:251], v[224:239]
    buffer_store_dwordx4 v[196:199], v7, s[24:27], s32 offen offset:1024 sc1
    v_mfma_f32_32x32x16_bf16 v[224:239], v[124:127], v[252:255], v[224:239]
    ds_read_b64_tr_b16 v[240:241], v2 offset:14400
    ds_read_b64_tr_b16 v[242:243], v2 offset:15296
    ds_read_b64_tr_b16 v[244:245], v2 offset:14432
    ds_read_b64_tr_b16 v[246:247], v2 offset:15328
    v_cvt_pk_bf16_f32 v208, v208, v209
    s_waitcnt lgkmcnt(4)
    s_nop 0
    v_mfma_f32_32x32x16_bf16 v[128:143], v[8:11], v[16:19], 0
    ds_read_b64_tr_b16 v[248:249], v2 offset:17920
    ds_read_b64_tr_b16 v[250:251], v2 offset:18816
    ds_read_b64_tr_b16 v[252:253], v2 offset:17952
    ds_read_b64_tr_b16 v[254:255], v2 offset:18848
    v_cvt_pk_bf16_f32 v209, v210, v211
    v_cvt_pk_bf16_f32 v210, v212, v213
    v_mfma_f32_32x32x16_bf16 v[144:159], v[12:15], v[16:19], 0
    ds_read_b64_tr_b16 v[8:9], v2 offset:17984
    ds_read_b64_tr_b16 v[10:11], v2 offset:18880
    v_cvt_pk_bf16_f32 v211, v214, v215
    v_cvt_pk_bf16_f32 v212, v216, v217
    v_cvt_pk_bf16_f32 v213, v218, v219
    s_waitcnt lgkmcnt(6)
    s_nop 0
    v_mfma_f32_32x32x16_bf16 v[160:175], v[240:243], v[16:19], 0
    ds_read_b64_tr_b16 v[12:13], v2 offset:18016
    ds_read_b64_tr_b16 v[14:15], v2 offset:18912
    v_cvt_pk_bf16_f32 v214, v220, v221
    v_cvt_pk_bf16_f32 v215, v222, v223
    v_cndmask_b32 v208, v6, v208, s[38:39]
    v_cndmask_b32 v209, v6, v209, s[38:39]
    v_mfma_f32_32x32x16_bf16 v[176:191], v[244:247], v[16:19], 0
    ds_read_b64_tr_b16 v[240:241], v2 offset:14464
    ds_read_b64_tr_b16 v[242:243], v2 offset:15360
    v_cndmask_b32 v210, v6, v210, s[38:39]
    v_cndmask_b32 v211, v6, v211, s[38:39]
    v_cndmask_b32 v212, v6, v212, s[38:39]
    s_waitcnt lgkmcnt(6)
    s_nop 0
    v_mfma_f32_32x32x16_bf16 v[128:143], v[248:251], v[20:23], v[128:143]
    ds_read_b64_tr_b16 v[244:245], v2 offset:18048
    ds_read_b64_tr_b16 v[246:247], v2 offset:18944
    v_cndmask_b32 v213, v6, v213, s[38:39]
    v_cndmask_b32 v214, v6, v214, s[38:39]
    v_cndmask_b32 v215, v6, v215, s[38:39]
    v_cvt_pk_bf16_f32 v224, v224, v225
    v_mfma_f32_32x32x16_bf16 v[144:159], v[252:255], v[20:23], v[144:159]
    buffer_store_dwordx4 v[208:211], v7, s[24:27], s33 offen offset:0 sc1
    s_waitcnt lgkmcnt(4)
    s_nop 0
    v_mfma_f32_32x32x16_bf16 v[160:175], v[8:11], v[20:23], v[160:175]
    buffer_store_dwordx4 v[212:215], v7, s[24:27], s33 offen offset:1024 sc1
    v_mfma_f32_32x32x16_bf16 v[176:191], v[12:15], v[20:23], v[176:191]
    ds_read_b64_tr_b16 v[248:249], v2 offset:43008
    ds_read_b64_tr_b16 v[250:251], v2 offset:43904
    ds_read_b64_tr_b16 v[252:253], v2 offset:43040
    ds_read_b64_tr_b16 v[254:255], v2 offset:43936
    v_cvt_pk_bf16_f32 v225, v226, v227
    s_waitcnt lgkmcnt(4)
    s_nop 0
    v_mfma_f32_32x32x16_bf16 v[192:207], v[240:243], v[16:19], 0
    ds_read_b64_tr_b16 v[8:9], v2 offset:43072
    ds_read_b64_tr_b16 v[10:11], v2 offset:43968
    ds_read_b64_tr_b16 v[12:13], v2 offset:43104
    ds_read_b64_tr_b16 v[14:15], v2 offset:44000
    v_cvt_pk_bf16_f32 v226, v228, v229
    v_cvt_pk_bf16_f32 v227, v230, v231
    v_mfma_f32_32x32x16_bf16 v[192:207], v[244:247], v[20:23], v[192:207]
    ds_read_b64_tr_b16 v[240:241], v2 offset:43136
    ds_read_b64_tr_b16 v[242:243], v2 offset:44032
    v_cvt_pk_bf16_f32 v228, v232, v233
    v_cvt_pk_bf16_f32 v229, v234, v235
    v_cvt_pk_bf16_f32 v230, v236, v237
    s_waitcnt lgkmcnt(6)
    s_nop 0
    v_mfma_f32_32x32x16_bf16 v[128:143], v[248:251], v[24:27], v[128:143]
    ds_read_b64_tr_b16 v[244:245], v2 offset:46592
    ds_read_b64_tr_b16 v[246:247], v2 offset:47488
    v_cvt_pk_bf16_f32 v231, v238, v239
    v_cndmask_b32 v224, v6, v224, s[38:39]
    v_cndmask_b32 v225, v6, v225, s[38:39]
    v_cndmask_b32 v226, v6, v226, s[38:39]
    v_mfma_f32_32x32x16_bf16 v[144:159], v[252:255], v[24:27], v[144:159]
    ds_read_b64_tr_b16 v[248:249], v2 offset:46624
    ds_read_b64_tr_b16 v[250:251], v2 offset:47520
    v_cndmask_b32 v227, v6, v227, s[38:39]
    v_cndmask_b32 v228, v6, v228, s[38:39]
    v_cndmask_b32 v229, v6, v229, s[38:39]
    s_waitcnt lgkmcnt(6)
    s_nop 0
    v_mfma_f32_32x32x16_bf16 v[160:175], v[8:11], v[24:27], v[160:175]
    ds_read_b64_tr_b16 v[252:253], v2 offset:46656
    ds_read_b64_tr_b16 v[254:255], v2 offset:47552
    v_cndmask_b32 v230, v6, v230, s[38:39]
    v_cndmask_b32 v231, v6, v231, s[38:39]
    v_mfma_f32_32x32x16_bf16 v[176:191], v[12:15], v[24:27], v[176:191]
    ds_read_b32 v5, v3 offset:4
    ds_read_b64_tr_b16 v[8:9], v2 offset:14496
    ds_read_b64_tr_b16 v[10:11], v2 offset:15392
    s_waitcnt lgkmcnt(7)
    v_mfma_f32_32x32x16_bf16 v[192:207], v[240:243], v[24:27], v[192:207]
    buffer_store_dwordx4 v[224:227], v7, s[24:27], s34 offen offset:0 sc1
    v_mfma_f32_32x32x16_bf16 v[128:143], v[244:247], v[28:31], v[128:143]
    s_waitcnt lgkmcnt(2)
    v_cmp_gt_u32_e64 vcc, 4, v5
    ds_read_b64_tr_b16 v[12:13], v2 offset:18080
    ds_read_b64_tr_b16 v[14:15], v2 offset:18976
    ds_read_b64_tr_b16 v[240:241], v2 offset:43168
    ds_read_b64_tr_b16 v[242:243], v2 offset:44064
    v_mfma_f32_32x32x16_bf16 v[144:159], v[248:251], v[28:31], v[144:159]
    s_cbranch_vccnz L_gate1v
L_gate1v_x:
    s_nop 0
    buffer_store_dwordx4 v[228:231], v7, s[24:27], s34 offen offset:1024 sc1
    v_mfma_f32_32x32x16_bf16 v[160:175], v[252:255], v[28:31], v[160:175]
    ds_read_b64_tr_b16 v[244:245], v2 offset:46688
    ds_read_b64_tr_b16 v[246:247], v2 offset:47584
    ds_read_b64_tr_b16 v[248:249], v2 offset:46720
    ds_read_b64_tr_b16 v[250:251], v2 offset:47616
    s_waitcnt lgkmcnt(6)
    s_nop 0
    v_mfma_f32_32x32x16_bf16 v[208:223], v[8:11], v[16:19], 0
    ds_read_b64_tr_b16 v[252:253], v2 offset:46752
    ds_read_b64_tr_b16 v[254:255], v2 offset:47648
    v_mfma_f32_32x32x16_bf16 v[208:223], v[12:15], v[20:23], v[208:223]
    ds_read_b64_tr_b16 v[8:9], v2 offset:21504
    ds_read_b64_tr_b16 v[10:11], v2 offset:22400
    s_waitcnt lgkmcnt(6)
    s_nop 0
    v_mfma_f32_32x32x16_bf16 v[208:223], v[240:243], v[24:27], v[208:223]
    ds_read_b64_tr_b16 v[12:13], v2 offset:21536
    ds_read_b64_tr_b16 v[14:15], v2 offset:22432
    v_mfma_f32_32x32x16_bf16 v[176:191], v[244:247], v[28:31], v[176:191]
    ds_read_b64_tr_b16 v[240:241], v2 offset:21568
    ds_read_b64_tr_b16 v[242:243], v2 offset:22464
    s_waitcnt lgkmcnt(6)
    s_nop 0
    v_mfma_f32_32x32x16_bf16 v[192:207], v[248:251], v[28:31], v[192:207]
    ds_read_b64_tr_b16 v[244:245], v2 offset:21600
    ds_read_b64_tr_b16 v[246:247], v2 offset:22496
    v_mfma_f32_32x32x16_bf16 v[208:223], v[252:255], v[28:31], v[208:223]
    ds_read_b64_tr_b16 v[248:249], v2 offset:14528
    ds_read_b64_tr_b16 v[250:251], v2 offset:15424
    s_waitcnt lgkmcnt(6)
    s_nop 0
    v_mfma_f32_32x32x16_bf16 v[128:143], v[8:11], v[32:35], v[128:143]
    ds_read_b64_tr_b16 v[252:253], v2 offset:18112
    ds_read_b64_tr_b16 v[254:255], v2 offset:19008
    v_mfma_f32_32x32x16_bf16 v[144:159], v[12:15], v[32:35], v[144:159]
    ds_read_b64_tr_b16 v[8:9], v2 offset:43200
    ds_read_b64_tr_b16 v[10:11], v2 offset:44096
    s_waitcnt lgkmcnt(6)
    s_nop 0
    v_mfma_f32_32x32x16_bf16 v[160:175], v[240:243], v[32:35], v[160:175]
    ds_read_b64_tr_b16 v[12:13], v2 offset:46784
    ds_read_b64_tr_b16 v[14:15], v2 offset:47680
    v_mfma_f32_32x32x16_bf16 v[176:191], v[244:247], v[32:35], v[176:191]
    ds_read_b64_tr_b16 v[240:241], v2 offset:21632
    ds_read_b64_tr_b16 v[242:243], v2 offset:22528
    s_waitcnt lgkmcnt(6)
    s_nop 0
    v_mfma_f32_32x32x16_bf16 v[224:239], v[248:251], v[16:19], 0
    ds_read_b64_tr_b16 v[244:245], v2 offset:21664
    ds_read_b64_tr_b16 v[246:247], v2 offset:22560
    v_mfma_f32_32x32x16_bf16 v[224:239], v[252:255], v[20:23], v[224:239]
    ds_read_b64_tr_b16 v[248:249], v2 offset:21696
    ds_read_b64_tr_b16 v[250:251], v2 offset:22592
    ds_read_b64_tr_b16 v[16:17], v2 offset:25088
    ds_read_b64_tr_b16 v[18:19], v2 offset:25984
    s_waitcnt lgkmcnt(8)
    s_nop 0
    v_mfma_f32_32x32x16_bf16 v[224:239], v[8:11], v[24:27], v[224:239]
    ds_read_b64_tr_b16 v[252:253], v2 offset:25120
    ds_read_b64_tr_b16 v[254:255], v2 offset:26016
    ds_read_b64_tr_b16 v[20:21], v2 offset:25152
    ds_read_b64_tr_b16 v[22:23], v2 offset:26048
    v_mfma_f32_32x32x16_bf16 v[224:239], v[12:15], v[28:31], v[224:239]
    s_mov_b64 exec, 1
    ds_add_u32 v3, v4 offset:32
    s_mov_b64 exec, -1
    ds_read_b64_tr_b16 v[8:9], v2 offset:25184
    ds_read_b64_tr_b16 v[10:11], v2 offset:26080
    ds_read_b64_tr_b16 v[24:25], v2 offset:25216
    ds_read_b64_tr_b16 v[26:27], v2 offset:26112
    s_branch L_pav_x
L_gq0:
    ds_read_b32 v5, v3 offset:28
    s_waitcnt lgkmcnt(0)
    v_cmp_gt_u32 vcc, 4, v5
    s_nop 3
    s_cbranch_vccnz L_gq0
    s_branch L_gq0_x
L_gq24v:
    ds_read_b32 v5, v3 offset:56
    s_waitcnt lgkmcnt(0)
    v_cmp_gt_u32 vcc, 4, v5
    s_nop 3
    s_cbranch_vccnz L_gq24v
    s_branch L_gq24v_x
L_gq48v:
    ds_read_b32 v5, v3 offset:60
    s_waitcnt lgkmcnt(0)
    v_cmp_gt_u32 vcc, 4, v5
    s_nop 3
    s_cbranch_vccnz L_gq48v
    s_branch L_gq48v_x
L_gq60v:
    ds_read_b32 v5, v3 offset:104
    s_waitcnt lgkmcnt(0)
    v_cmp_gt_u32 vcc, 4, v5
    s_nop 3
    s_cbranch_vccnz L_gq60v
    s_branch L_gq60v_x
L_gq72v:
    ds_read_b32 v5, v3 offset:108
    s_waitcnt lgkmcnt(0)
    v_cmp_gt_u32 vcc, 4, v5
    s_nop 3
    s_cbranch_vccnz L_gq72v
    s_branch L_gq72v_x
L_gate0v:
    ds_read_b32 v5, v3 offset:0
    s_waitcnt lgkmcnt(0)
    v_cmp_gt_u32 vcc, 4, v5
    s_nop 3
    s_cbranch_vccnz L_gate0v
    s_branch L_gate0v_x
L_gate1v:
    ds_read_b32 v5, v3 offset:4
    s_waitcnt lgkmcnt(0)
    v_cmp_gt_u32 vcc, 4, v5
    s_nop 3
    s_cbranch_vccnz L_gate1v
    s_branch L_gate1v_x
L_gq24:
    ds_read_b32 v5, v3 offset:56
    s_waitcnt lgkmcnt(0)
    v_cmp_gt_u32 vcc, 4, v5
    s_nop 3
    s_cbranch_vccnz L_gq24
    s_branch L_gq24_x
L_gq48:
    ds_read_b32 v5, v3 offset:60
    s_waitcnt lgkmcnt(0)
    v_cmp_gt_u32 vcc, 4, v5
    s_nop 3
    s_cbranch_vccnz L_gq48
    s_branch L_gq48_x
L_gq60:
    ds_read_b32 v5, v3 offset:104
    s_waitcnt lgkmcnt(0)
    v_cmp_gt_u32 vcc, 4, v5
    s_nop 3
    s_cbranch_vccnz L_gq60
    s_branch L_gq60_x
L_gq72:
    ds_read_b32 v5, v3 offset:108
    s_waitcnt lgkmcnt(0)
    v_cmp_gt_u32 vcc, 4, v5
    s_nop 3
    s_cbranch_vccnz L_gq72
    s_branch L_gq72_x
L_gate0:
    ds_read_b32 v5, v3 offset:0
    s_waitcnt lgkmcnt(0)
    v_cmp_gt_u32 vcc, 4, v5
    s_nop 3
    s_cbranch_vccnz L_gate0
    s_branch L_gate0_x
L_gate1:
    ds_read_b32 v5, v3 offset:4
    s_waitcnt lgkmcnt(0)
    v_cmp_gt_u32 vcc, 4, v5
    s_nop 3
    s_cbranch_vccnz L_gate1
    s_branch L_gate1_x
L_gate2:
    ds_read_b32 v5, v3 offset:8
    s_waitcnt lgkmcnt(0)
    v_cmp_gt_u32 vcc, 4, v5
    s_nop 3
    s_cbranch_vccnz L_gate2
    s_branch L_gate2_x
L_gate3:
    ds_read_b32 v5, v3 offset:12
    s_waitcnt lgkmcnt(0)
    v_cmp_gt_u32 vcc, 4, v5
    s_nop 3
    s_cbranch_vccnz L_gate3
    s_branch L_gate3_x
L_gate4:
    ds_read_b32 v5, v3 offset:16
    s_waitcnt lgkmcnt(0)
    v_cmp_gt_u32 vcc, 4, v5
    s_nop 3
    s_cbranch_vccnz L_gate4
    s_branch L_gate4_x
L_gate5:
    ds_read_b32 v5, v3 offset:20
    s_waitcnt lgkmcnt(0)
    v_cmp_gt_u32 vcc, 4, v5
    s_nop 3
    s_cbranch_vccnz L_gate5
    s_branch L_gate5_x
L_gate6:
    ds_read_b32 v5, v3 offset:24
    s_waitcnt lgkmcnt(0)
    v_cmp_gt_u32 vcc, 4, v5
    s_nop 3
    s_cbranch_vccnz L_gate6
    s_branch L_gate6_x
L_wol:
    ds_read_b32 v5, v3 offset:64
    s_waitcnt lgkmcnt(0)
    v_cmp_gt_u32 vcc, 4, v5
    s_nop 3
    s_cbranch_vccnz L_wol
    s_branch L_wol_x
L_r1:
    ds_read_b32 v5, v3 offset:72
    s_waitcnt lgkmcnt(0)
    v_cmp_gt_u32 vcc, 4, v5
    s_nop 3
    s_cbranch_vccnz L_r1
    s_branch L_r1_x
L_mix:
    v_mov_b32 v232, 0x3f80
    v_cndmask_b32 v230, v230, v232, s[42:43]
    s_lshl_b32 s51, s44, 11
    s_add_u32 s51, s51, 32768
    v_lshrrev_b32 v237, 5, v0
    v_and_b32 v232, 31, v0
    v_lshlrev_b32_e64 v232, 6, v232
    v_lshl_add_u32 v232, v237, 3, v232
    v_bfe_u32 v233, v0, 1, 2
    v_lshl_add_u32 v232, v233, 4, v232
    v_add_u32 v232, s51, v232
    v_xor_b32 v233, 16, v232
    v_xor_b32 v234, 32, v232
    v_xor_b32 v235, 48, v232
    v_bfe_u32 v236, v0, 2, 2
    v_lshl_add_u32 v236, v237, 2, v236
    v_lshrrev_b32 v237, 1, v236
    v_lshlrev_b32 v237, 4, v237
    v_and_b32 v238, 3, v0
    v_lshlrev_b32 v238, 3, v238
    v_bfe_u32 v239, v0, 4, 1
    v_lshl_add_u32 v238, v239, 5, v238
    v_xor_b32 v237, v237, v238
    v_lshlrev_b32 v236, 6, v236
    v_add3_u32 v236, v236, v237, s51
    s_mov_b64 s[56:57], vcc
L_mixw:
    ds_read_b32 v237, v3 offset:92
    s_waitcnt lgkmcnt(0)
    v_cmp_gt_u32 vcc, 4, v237
    s_nop 3
    s_cbranch_vccnz L_mixw
    s_mov_b64 vcc, s[56:57]
    ds_write_b64 v232, v[224:225]
    ds_write_b64 v233, v[226:227]
    ds_write_b64 v234, v[228:229]
    ds_write_b64 v235, v[230:231]
    ds_read_b64_tr_b16 v[224:225], v236 offset:0
    ds_read_b64_tr_b16 v[226:227], v236 offset:512
    ds_read_b64_tr_b16 v[228:229], v236 offset:1024
    ds_read_b64_tr_b16 v[230:231], v236 offset:1536
    s_waitcnt lgkmcnt(0)
    s_branch L_mix_x
L_compute:
    s_and_b32 s46, s48, 1
    s_lshl_b32 s46, s46, 3
    s_add_u32 s46, s46, s50
    s_lshr_b32 s45, s48, 1
    s_lshl_b32 s45, s45, 2
    s_add_u32 s45, s45, s51
    s_lshl_b32 s49, s48, 2
    s_add_u32 s49, s49, s51
    s_lshl_b32 s3, s51, 1
    s_add_u32 s64, s3, s50
    s_cmp_ge_u32 s64, 7
    s_cselect_b32 s62, 7, 0
    s_sub_u32 s64, s64, s62
    s_cmp_ge_u32 s50, 7
    s_cselect_b32 s3, 3, s50
    s_lshl_b32 s52, s45, 2
    s_add_u32 s52, s52, s44
    v_mov_b32 v196, 0
    v_mov_b32 v197, 0
    v_mov_b32 v198, 0
    v_mov_b32 v199, 0
    v_min_u32 v240, 11, v0
    v_and_b32 v241, 3, v240
    v_lshrrev_b32 v240, 2, v240
    v_lshlrev_b32_e64 v240, 15, v240
    v_lshl_add_u32 v240, v241, 7, v240
    s_lshl_b32 s51, s52, 9
    s_add_u32 s51, s51, 16777216
    s_waitcnt lgkmcnt(0)
    s_mov_b32 s24, s22
    s_mov_b32 s25, s23
    s_mov_b32 s26, 16875520
    s_mov_b32 s27, 0x00020000
    s_xor_b32 s59, s46, 7
    s_cbranch_scc1 L_noclr
    buffer_store_dword v196, v240, s[24:27], s51 offen sc1
L_noclr:
    s_mov_b32 s28, s6
    s_mov_b32 s29, s7
    s_mov_b32 s30, 1204224
    s_mov_b32 s31, 0x00020000
    s_cmp_ge_u32 s46, 8
    s_cselect_b32 s62, 0xc9888d99, 0
    s_xor_b32 s62, s62, 0x67543210
    s_lshl_b32 s51, s46, 2
    s_lshr_b32 s51, s62, s51
    s_and_b32 s51, s51, 15
    s_mul_i32 s51, s51, 168
    s_and_b32 s51, s51, -16
    v_add_u32 v240, 0, v0
    v_mul_u32_u24 v241, 5462, v240
    v_lshrrev_b32 v241, 16, v241
    v_mul_u32_u24 v242, 12, v241
    v_sub_u32 v242, v240, v242
    v_min_u32 v242, 10, v242
    v_mul_u32_u24 v241, 2688, v241
    v_lshl_add_u32 v241, v242, 4, v241
    v_add_u32 v216, s51, v241
    v_add_u32 v240, 64, v0
    v_mul_u32_u24 v241, 5462, v240
    v_lshrrev_b32 v241, 16, v241
    v_mul_u32_u24 v242, 12, v241
    v_sub_u32 v242, v240, v242
    v_min_u32 v242, 10, v242
    v_mul_u32_u24 v241, 2688, v241
    v_lshl_add_u32 v241, v242, 4, v241
    v_subrev_u32 v241, 1024, v241
    v_add_u32_e64 v217, s51, v241
    v_add_u32 v240, 128, v0
    v_mul_u32_u24 v241, 5462, v240
    v_lshrrev_b32 v241, 16, v241
    v_mul_u32_u24 v242, 12, v241
    v_sub_u32 v242, v240, v242
    v_min_u32 v242, 10, v242
    v_mul_u32_u24 v241, 2688, v241
    v_lshl_add_u32 v241, v242, 4, v241
    v_subrev_u32 v241, 2048, v241
    v_add_u32_e64 v218, s51, v241
    s_mul_i32 s70, s44, 43008
    s_mul_i32 s71, s44, 3072
    s_mul_i32 s72, s3, 172032
    s_mul_i32 s73, s44, 28672
    s_add_u32 s73, s73, 49152
    s_cmp_ge_u32 s44, 2
    s_cselect_b32 s32, s14, s12
    s_cselect_b32 s33, s15, s13
    s_mov_b32 s34, 1605632
    s_mov_b32 s35, 0x00020000
    s_cselect_b32 s51, 128, 0
    s_mul_i32 s53, s44, 28672
    s_add_u32 s53, s53, s51
    s_add_u32 s53, s53, 49024
    s_mul_i32 s42, s44, 7168
    s_add_u32 s42, s42, s51
    s_and_b32 s51, s44, 1
    s_mul_i32 s54, s51, 114688
    s_mul_i32 s51, s46, 224
    v_add_u32_e64 v240, 0, v0
    v_mul_u32_u24 v241, 4682, v240
    v_lshrrev_b32_e64 v241, 16, v241
    v_mul_u32_u24 v242, 3360, v241
    v_lshl_add_u32 v242, v240, 4, v242
    v_add_u32 v208, s51, v242
    v_add_u32 v240, 64, v0
    v_mul_u32_u24 v241, 4682, v240
    v_lshrrev_b32_e64 v241, 16, v241
    v_mul_u32_u24 v242, 3360, v241
    v_lshl_add_u32 v242, v240, 4, v242
    v_subrev_u32 v242, 1024, v242
    v_add_u32_e64 v209, s51, v242
    v_add_u32 v240, 128, v0
    v_mul_u32_u24 v241, 4682, v240
    v_lshrrev_b32_e64 v241, 16, v241
    v_mul_u32_u24 v242, 3360, v241
    v_lshl_add_u32 v242, v240, 4, v242
    v_subrev_u32 v242, 2048, v242
    v_add_u32_e64 v210, s51, v242
    v_add_u32 v240, 192, v0
    v_mul_u32_u24 v241, 4682, v240
    v_lshrrev_b32_e64 v241, 16, v241
    v_mul_u32_u24 v242, 3360, v241
    v_lshl_add_u32 v242, v240, 4, v242
    v_subrev_u32 v242, 3072, v242
    v_add_u32_e64 v211, s51, v242
    v_add_u32 v240, 256, v0
    v_mul_u32_u24 v241, 4682, v240
    v_lshrrev_b32_e64 v241, 16, v241
    v_mul_u32_u24 v242, 3360, v241
    v_lshl_add_u32 v242, v240, 4, v242
    v_add_u32_e64 v212, s51, v242
    v_add_u32 v240, 320, v0
    v_mul_u32_u24 v241, 4682, v240
    v_lshrrev_b32_e64 v241, 16, v241
    v_mul_u32_u24 v242, 3360, v241
    v_lshl_add_u32 v242, v240, 4, v242
    v_subrev_u32 v242, 1024, v242
    v_add_u32_e64 v213, s51, v242
    v_add_u32 v240, 384, v0
    v_mul_u32_u24 v241, 4682, v240
    v_lshrrev_b32_e64 v241, 16, v241
    v_mul_u32_u24 v242, 3360, v241
    v_lshl_add_u32 v242, v240, 4, v242
    v_subrev_u32 v242, 2048, v242
    v_add_u32_e64 v214, s51, v242
    s_mov_b32 s12, s20
    s_mov_b32 s13, s21
    s_mov_b32 s14, 256
    s_mov_b32 s15, 0x00020000
    s_mov_b32 s36, s16
    s_mov_b32 s37, s17
    s_mov_b32 s38, 1605632
    s_mov_b32 s39, 0x00020000
    s_mov_b32 s16, s8
    s_mov_b32 s17, s9
    s_mov_b32 s18, 401408
    s_mov_b32 s19, 0x00020000
    s_mov_b32 s40, 0
    s_mov_b32 s41, -1
    v_lshlrev_b32 v15, 4, v0
    v_lshlrev_b32 v13, 25, v0
    v_mov_b32_e64 v14, 1
    v_mov_b32 v12, 106368
    v_and_b32 v222, 15, v0
    v_lshlrev_b32 v222, 4, v222
    s_lshl_b32 s74, s45, 4
    v_mov_b32 v188, 0
    v_mov_b32 v189, 0
    v_mov_b32 v190, 0
    v_mov_b32 v191, 0
    v_mov_b32 v16, 0
    v_mov_b32 v17, 0
    v_mov_b32 v18, 0
    v_mov_b32 v19, 0
    v_mov_b32 v20, 0
    v_mov_b32 v21, 0
    v_mov_b32 v22, 0
    v_mov_b32 v23, 0
    v_mov_b32 v24, 0
    v_mov_b32 v25, 0
    v_mov_b32 v26, 0
    v_mov_b32 v27, 0
    v_mov_b32 v28, 0
    v_mov_b32 v29, 0
    v_mov_b32 v30, 0
    v_mov_b32 v31, 0
    v_mov_b32 v32, 0
    v_mov_b32 v33, 0
    v_mov_b32 v34, 0
    v_mov_b32 v35, 0
    v_mov_b32 v36, 0
    v_mov_b32 v37, 0
    v_mov_b32 v38, 0
    v_mov_b32 v39, 0
    v_mov_b32 v40, 0
    v_mov_b32 v41, 0
    v_mov_b32 v42, 0
    v_mov_b32 v43, 0
    v_mov_b32 v44, 0
    v_mov_b32 v45, 0
    v_mov_b32 v46, 0
    v_mov_b32 v47, 0
    v_mov_b32 v48, 0
    v_mov_b32 v49, 0
    v_mov_b32 v50, 0
    v_mov_b32 v51, 0
    v_mov_b32 v52, 0
    v_mov_b32 v53, 0
    v_mov_b32 v54, 0
    v_mov_b32 v55, 0
    v_mov_b32 v56, 0
    v_mov_b32 v57, 0
    v_mov_b32 v58, 0
    v_mov_b32 v59, 0
    v_mov_b32 v60, 0
    v_mov_b32 v61, 0
    v_mov_b32 v62, 0
    v_mov_b32 v63, 0
    v_mov_b32 v64, 0
    v_mov_b32 v65, 0
    v_mov_b32 v66, 0
    v_mov_b32 v67, 0
    v_mov_b32 v68, 0
    v_mov_b32 v69, 0
    v_mov_b32 v70, 0
    v_mov_b32 v71, 0
    v_mov_b32 v72, 0
    v_mov_b32 v73, 0
    v_mov_b32 v74, 0
    v_mov_b32 v75, 0
    v_mov_b32 v76, 0
    v_mov_b32 v77, 0
    v_mov_b32 v78, 0
    v_mov_b32_e64 v79, 0
    s_barrier
    s_setprio 0
    s_add_u32 m0, s71, 0
    s_add_u32 s51, s72, s70
    buffer_load_dwordx4 v216, s[28:31], s51 offen offset:0 lds
    buffer_load_dwordx4 v217, s[28:31], s51 offen offset:1024 lds
    buffer_load_dwordx4 v218, s[28:31], s51 offen offset:2048 lds
    s_add_u32 s72, s72, 172032
    s_cmp_ge_u32 s72, 1204224
    s_cselect_b32 s72, 0, s72
    s_add_u32 m0, s71, 12288
    s_add_u32 s51, s72, s70
    buffer_load_dwordx4 v216, s[28:31], s51 offen offset:0 lds
    buffer_load_dwordx4 v217, s[28:31], s51 offen offset:1024 lds
    buffer_load_dwordx4 v218, s[28:31], s51 offen offset:2048 lds
    s_add_u32 s72, s72, 172032
    s_cmp_ge_u32 s72, 1204224
    s_cselect_b32 s72, 0, s72
    v_min_u32 v8, 9, v0
    v_lshlrev_b32_e64 v8, 7, v8
    s_lshl_b32 s51, s2, 2
    s_add_u32 s51, s51, s44
    s_mul_i32 s51, s51, 1176
    s_add_u32 s51, s51, 0
    buffer_load_dword v221, v8, s[28:31], s51 offen
    v_min_u32 v5, 24, v0
    v_lshlrev_b32 v5, 7, v5
    s_lshl_b32 s51, s2, 1
    s_and_b32 s62, s44, 1
    s_add_u32 s51, s51, s62
    s_mul_i32 s51, s51, 3136
    s_add_u32 s51, s51, 0
    buffer_load_dword v221, v5, s[32:35], s51 offen
    s_barrier
    s_lshl_b32 s76, s45, 4
    s_add_u32 s76, s76, s46
    s_lshl_b32 s76, s76, 7
    s_add_u32 s76, s76, 16777216
    s_mov_b32 s75, s44
    s_add_u32 m0, s71, 24576
    s_add_u32 s51, s72, s70
    s_nop 0
    buffer_load_dwordx4 v216, s[28:31], s51 offen offset:0 lds
    buffer_load_dwordx4 v217, s[28:31], s51 offen offset:1024 lds
    buffer_load_dwordx4 v218, s[28:31], s51 offen offset:2048 lds
    s_add_u32 s72, s72, 172032
    s_cmp_ge_u32 s72, 1204224
    s_cselect_b32 s72, 0, s72
    s_add_u32 m0, s71, 36864
    s_add_u32 s51, s72, s70
    buffer_load_dwordx4 v216, s[28:31], s51 offen offset:0 lds
    buffer_load_dwordx4 v217, s[28:31], s51 offen offset:1024 lds
    buffer_load_dwordx4 v218, s[28:31], s51 offen offset:2048 lds
    s_waitcnt vmcnt(8)
    s_mov_b64 exec, 1
    ds_add_u32 v12, v14 offset:28
    s_mov_b64 exec, -1
    s_add_u32 s72, s72, 172032
    s_cmp_ge_u32 s72, 1204224
    s_cselect_b32 s72, 0, s72
    s_add_u32 m0, s73, 0
    s_add_u32 s51, s72, s70
    buffer_load_dwordx4 v216, s[28:31], s51 offen offset:0 lds
    buffer_load_dwordx4 v217, s[28:31], s51 offen offset:1024 lds
    buffer_load_dwordx4 v218, s[28:31], s51 offen offset:2048 lds
    s_add_u32 s72, s72, 172032
    s_cmp_ge_u32 s72, 1204224
    s_cselect_b32 s72, 0, s72
    s_add_u32 m0, s73, 7168
    s_add_u32 s51, s72, s70
    buffer_load_dwordx4 v216, s[28:31], s51 offen offset:0 lds
    buffer_load_dwordx4 v217, s[28:31], s51 offen offset:1024 lds
    buffer_load_dwordx4 v218, s[28:31], s51 offen offset:2048 lds
    s_add_u32 s72, s72, 172032
    s_cmp_ge_u32 s72, 1204224
    s_cselect_b32 s72, 0, s72
    s_add_u32 m0, s73, 10240
    s_add_u32 s51, s72, s70
    buffer_load_dwordx4 v216, s[28:31], s51 offen offset:0 lds
    buffer_load_dwordx4 v217, s[28:31], s51 offen offset:1024 lds
    buffer_load_dwordx4 v218, s[28:31], s51 offen offset:2048 lds
    s_waitcnt vmcnt(9)
    s_mov_b64 exec, 1
    ds_add_u32 v12, v14 offset:56
    s_mov_b64 exec, -1
    s_add_u32 m0, s53, 14336
    s_add_u32 s43, s3, 0
    s_cmp_ge_u32 s43, 7
    s_cselect_b32 s62, 7, 0
    s_sub_u32 s43, s43, s62
    s_mul_i32 s43, s43, 229376
    s_add_u32 s43, s43, s54
    buffer_load_dwordx4 v208, s[32:35], s43 offen offset:0 lds
    buffer_load_dwordx4 v209, s[32:35], s43 offen offset:1024 lds
    buffer_load_dwordx4 v210, s[32:35], s43 offen offset:2048 lds
    s_waitcnt vmcnt(9)
    s_mov_b64 exec, 1
    ds_add_u32 v12, v14 offset:60
    s_mov_b64 exec, -1
    buffer_load_dwordx4 v211, s[32:35], s43 offen offset:3072 lds
    s_add_u32 m0, s53, 18432
    s_nop 0
    buffer_load_dwordx4 v212, s[32:35], s43 offen offset:0 lds
    buffer_load_dwordx4 v213, s[32:35], s43 offen offset:1024 lds
    s_waitcnt vmcnt(9)
    s_mov_b64 exec, 1
    ds_add_u32 v12, v14 offset:104
    s_mov_b64 exec, -1
    buffer_load_dwordx4 v214, s[32:35], s43 offen offset:2048 lds
    s_add_u32 m0, s53, 21504
    s_add_u32 s43, s3, 1
    s_cmp_ge_u32 s43, 7
    s_cselect_b32 s62, 7, 0
    s_sub_u32 s43, s43, s62
    s_mul_i32 s43, s43, 229376
    s_add_u32 s43, s43, s54
    buffer_load_dwordx4 v208, s[32:35], s43 offen offset:0 lds
    buffer_load_dwordx4 v209, s[32:35], s43 offen offset:1024 lds
    s_waitcnt vmcnt(9)
    s_mov_b64 exec, 1
    ds_add_u32 v12, v14 offset:108
    s_mov_b64 exec, -1
    buffer_load_dwordx4 v210, s[32:35], s43 offen offset:2048 lds
    buffer_load_dwordx4 v211, s[32:35], s43 offen offset:3072 lds
    s_add_u32 m0, s53, 25600
    s_nop 0
    buffer_load_dwordx4 v212, s[32:35], s43 offen offset:0 lds
    buffer_load_dwordx4 v213, s[32:35], s43 offen offset:1024 lds
    buffer_load_dwordx4 v214, s[32:35], s43 offen offset:2048 lds
    s_or_b32 s59, s59, s44
    s_cbranch_scc1 L_nogo
L_clr:
    s_sleep 1
    ds_read_b32 v2, v12 offset:28
    s_waitcnt lgkmcnt(0)
    v_cmp_gt_u32_e64 vcc, 4, v2
    s_nop 3
    s_cbranch_vccnz L_clr
    buffer_store_dword v14, v13, s[12:15], s74 offen sc1
L_nogo:
L_cq2:
    s_sleep 1
    ds_read_b32 v2, v12 offset:88
    s_waitcnt lgkmcnt(0)
    v_cmp_gt_u32 vcc, 4, v2
    s_nop 3
    s_cbranch_vccnz L_cq2
    s_add_u32 m0, s42, 0
    s_add_u32 s43, s3, 2
    s_cmp_ge_u32 s43, 7
    s_cselect_b32 s62, 7, 0
    s_sub_u32 s43, s43, s62
    s_mul_i32 s43, s43, 229376
    s_add_u32 s43, s43, s54
    buffer_load_dwordx4 v208, s[32:35], s43 offen offset:0 lds
    buffer_load_dwordx4 v209, s[32:35], s43 offen offset:1024 lds
    s_waitcnt vmcnt(9)
    s_mov_b64 exec, 1
    ds_add_u32 v12, v14 offset:0
    s_mov_b64 exec, -1
    buffer_load_dwordx4 v210, s[32:35], s43 offen offset:2048 lds
    buffer_load_dwordx4 v211, s[32:35], s43 offen offset:3072 lds
    s_add_u32 m0, s42, 4096
    s_nop 0
    buffer_load_dwordx4 v212, s[32:35], s43 offen offset:0 lds
    buffer_load_dwordx4 v213, s[32:35], s43 offen offset:1024 lds
    buffer_load_dwordx4 v214, s[32:35], s43 offen offset:2048 lds
L_ce:
    s_sleep 1
    ds_read_b32 v2, v12 offset:92
    s_waitcnt lgkmcnt(0)
    v_cmp_gt_u32 vcc, 4, v2
    s_nop 3
    s_cbranch_vccnz L_ce
    s_add_u32 m0, s53, 0
    s_add_u32 s43, s3, 3
    s_cmp_ge_u32 s43, 7
    s_cselect_b32 s62, 7, 0
    s_sub_u32 s43, s43, s62
    s_mul_i32 s43, s43, 229376
    s_add_u32 s43, s43, s54
    buffer_load_dwordx4 v208, s[32:35], s43 offen offset:0 lds
    buffer_load_dwordx4 v209, s[32:35], s43 offen offset:1024 lds
    s_waitcnt vmcnt(9)
    s_mov_b64 exec, 1
    ds_add_u32 v12, v14 offset:4
    s_mov_b64 exec, -1
    buffer_load_dwordx4 v210, s[32:35], s43 offen offset:2048 lds
    buffer_load_dwordx4 v211, s[32:35], s43 offen offset:3072 lds
    s_add_u32 m0, s53, 4096
    s_nop 0
    buffer_load_dwordx4 v212, s[32:35], s43 offen offset:0 lds
    buffer_load_dwordx4 v213, s[32:35], s43 offen offset:1024 lds
    buffer_load_dwordx4 v214, s[32:35], s43 offen offset:2048 lds
    s_setprio 0
    s_lshl_b32 s65, s48, 1
    s_and_b32 s51, s47, 1
    s_add_u32 s65, s65, s51
    s_lshr_b32 s66, s47, 1
    v_bfe_u32 v242, v0, 2, 2
    v_bfe_u32 v244, v0, 4, 1
    s_lshl_b32 s51, s66, 2
    s_add_u32 s51, s51, s44
    s_mul_i32 s67, s51, 147456
    s_lshl_b32 s51, s65, 11
    s_add_u32 s67, s67, s51
    s_add_u32 s67, s67, 6406144
    s_lshl_b32 s51, s44, 2
    s_lshl_b32 s60, s66, 4
    s_add_u32 s60, s60, s65
    s_lshl_b32 s60, s60, 7
    s_add_u32 s60, s60, 16842752
    s_lshl_b32 s51, s65, 18
    s_lshl_b32 s58, s44, 16
    s_add_u32 s51, s51, s58
    s_add_u32 s51, s51, 2097152
    s_add_u32 s4, s22, s51
    s_addc_u32 s5, s23, 0
    s_mov_b32 s6, 0x10000
    s_mov_b32 s7, 0x00020000
    s_lshl_b32 s69, s66, 12
    s_add_u32 s51, s65, 0
    s_mul_i32 s51, s51, 43
    s_lshr_b32 s51, s51, 7
    s_cmp_ge_u32 s51, 8
    s_cselect_b32 s62, 0xc9888d99, 0
    s_xor_b32 s62, s62, 0x67543210
    s_lshl_b32 s51, s51, 2
    s_lshr_b32 s51, s62, s51
    s_and_b32 s51, s51, 15
    s_lshl_b32 s56, s51, 7
    s_add_u32 s51, s65, 16
    s_mul_i32 s51, s51, 43
    s_lshr_b32 s51, s51, 7
    s_cmp_ge_u32 s51, 8
    s_cselect_b32 s62, 0xc9888d99, 0
    s_xor_b32 s62, s62, 0x67543210
    s_lshl_b32 s51, s51, 2
    s_lshr_b32 s51, s62, s51
    s_and_b32 s51, s51, 15
    s_lshl_b32 s57, s51, 7
    s_add_u32 s51, s65, 32
    s_mul_i32 s51, s51, 43
    s_lshr_b32 s51, s51, 7
    s_cmp_ge_u32 s51, 8
    s_cselect_b32 s62, 0xc9888d99, 0
    s_xor_b32 s62, s62, 0x67543210
    s_lshl_b32 s51, s51, 2
    s_lshr_b32 s51, s62, s51
    s_and_b32 s51, s51, 15
    s_lshl_b32 s58, s51, 7
    s_lshl_b32 s51, s66, 11
    s_add_u32 s56, s56, s51
    s_lshl_b32 s51, s44, 13
    s_add_u32 s57, s57, s51
    s_add_u32 s58, s58, s51
    v_lshlrev_b32 v1, 11, v242
    v_add_u32 v246, s58, v1
    v_add_u32 v1, s57, v1
    v_cmp_eq_u32 vcc, 1, v244
    v_mov_b32_e64 v247, s56
    v_and_b32 v243, 3, v0
    v_cndmask_b32 v1, v1, v246, vcc
    v_cndmask_b32 v1, v1, v247, s[40:41]
    s_mov_b32 s68, 16777216
    s_add_u32 s51, s44, 0
    s_and_b32 s51, s51, 3
    s_mul_i32 s55, s51, 12288
    s_add_u32 s55, s55, 0
    v_add_u32 v204, s55, v15
    s_lshl_b32 s55, s65, 4
    s_add_u32 s55, s55, s66
    s_lshl_b32 s55, s55, 2
    s_add_u32 s55, s55, s51
    s_lshl_b32 s8, s55, 11
    s_add_u32 s51, s44, 1
    s_and_b32 s51, s51, 3
    s_mul_i32 s55, s51, 12288
    s_add_u32 s55, s55, 0
    v_add_u32 v205, s55, v15
    s_lshl_b32 s55, s65, 4
    s_add_u32 s55, s55, s66
    s_lshl_b32 s55, s55, 2
    s_add_u32 s55, s55, s51
    s_lshl_b32 s9, s55, 11
    s_add_u32 s51, s44, 2
    s_and_b32 s51, s51, 3
    s_mul_i32 s55, s51, 12288
    s_add_u32 s55, s55, 0
    v_add_u32 v206, s55, v15
    s_lshl_b32 s55, s65, 4
    s_add_u32 s55, s55, s66
    s_lshl_b32 s55, s55, 2
    s_add_u32 s55, s55, s51
    s_lshl_b32 s10, s55, 11
    s_add_u32 s51, s44, 3
    s_and_b32 s51, s51, 3
    s_mul_i32 s55, s51, 12288
    s_add_u32 s55, s55, 0
    v_add_u32 v207, s55, v15
    s_lshl_b32 s55, s65, 4
    s_add_u32 s55, s55, s66
    s_lshl_b32 s55, s55, 2
    s_add_u32 s55, s55, s51
    s_lshl_b32 s11, s55, 11
    s_mov_b32 s55, 0
    s_setprio 0
    s_waitcnt vmcnt(7)
    s_mov_b64 exec, 1
    ds_add_u32 v12, v14 offset:8
    s_mov_b64 exec, -1
L_cons5:
    s_sleep 1
    ds_read_b32 v2, v12 offset:32
    s_waitcnt lgkmcnt(0)
    v_cmp_gt_u32 vcc, 4, v2
    s_nop 3
    s_cbranch_vccnz L_cons5
    buffer_load_dword v223, v222, s[12:15], 0 offen sc1
    s_add_u32 m0, s53, 7168
    s_add_u32 s43, s3, 4
    s_cmp_ge_u32 s43, 7
    s_cselect_b32 s62, 7, 0
    s_sub_u32 s43, s43, s62
    s_mul_i32 s43, s43, 229376
    s_add_u32 s43, s43, s54
    s_nop 0
    buffer_load_dwordx4 v208, s[32:35], s43 offen offset:0 lds
    buffer_load_dwordx4 v209, s[32:35], s43 offen offset:1024 lds
    buffer_load_dwordx4 v210, s[32:35], s43 offen offset:2048 lds
    buffer_load_dwordx4 v211, s[32:35], s43 offen offset:3072 lds
    s_add_u32 m0, s53, 11264
    s_nop 0
    buffer_load_dwordx4 v212, s[32:35], s43 offen offset:0 lds
    buffer_load_dwordx4 v213, s[32:35], s43 offen offset:1024 lds
    buffer_load_dwordx4 v214, s[32:35], s43 offen offset:2048 lds
    s_add_u32 m0, s53, 14336
    s_add_u32 s43, s3, 5
    s_cmp_ge_u32 s43, 7
    s_cselect_b32 s62, 7, 0
    s_sub_u32 s43, s43, s62
    s_mul_i32 s43, s43, 229376
    s_add_u32 s43, s43, s54
    buffer_load_dwordx4 v208, s[32:35], s43 offen offset:0 lds
    s_waitcnt vmcnt(9)
    s_mov_b64 exec, 1
    ds_add_u32 v12, v14 offset:12
    s_mov_b64 exec, -1
    buffer_load_dwordx4 v209, s[32:35], s43 offen offset:1024 lds
    s_waitcnt vmcnt(9)
    v_cmp_gt_u32_e64 vcc, 1, v223
    s_nop 3
    s_cbranch_vccnz L_go
L_go_x:
    s_cmp_lg_u32 s75, 0
    s_cbranch_scc1 L_nofl0
    ds_read_b32 v2, v12 offset:116
    s_waitcnt lgkmcnt(0)
    v_cmp_gt_u32 vcc, 4, v2
    s_nop 3
    s_cbranch_vccnz L_nofl0
    buffer_store_dword v14, v13, s[24:27], s76 offen sc1
    s_mov_b32 s75, 1
L_nofl0:
    buffer_load_dwordx4 v210, s[32:35], s43 offen offset:2048 lds
    buffer_load_dwordx4 v211, s[32:35], s43 offen offset:3072 lds
    s_cmp_lg_u32 s75, 0
    s_cbranch_scc1 L_nofl1
    ds_read_b32 v2, v12 offset:116
    s_waitcnt lgkmcnt(0)
    v_cmp_gt_u32_e64 vcc, 4, v2
    s_nop 3
    s_cbranch_vccnz L_nofl1
    buffer_store_dword v14, v13, s[24:27], s76 offen sc1
    s_mov_b32 s75, 1
L_nofl1:
    s_add_u32 m0, s53, 18432
    s_nop 0
    buffer_load_dwordx4 v212, s[32:35], s43 offen offset:0 lds
    buffer_load_dwordx4 v213, s[32:35], s43 offen offset:1024 lds
    s_cmp_lg_u32 s75, 0
    s_cbranch_scc1 L_nofl2
    ds_read_b32 v2, v12 offset:116
    s_waitcnt lgkmcnt(0)
    v_cmp_gt_u32 vcc, 4, v2
    s_nop 3
    s_cbranch_vccnz L_nofl2
    buffer_store_dword v14, v13, s[24:27], s76 offen sc1
    s_mov_b32 s75, 1
L_nofl2:
    buffer_load_dwordx4 v214, s[32:35], s43 offen offset:2048 lds
L_cons6:
    s_sleep 1
    ds_read_b32 v2, v12 offset:36
    s_waitcnt lgkmcnt(0)
    v_cmp_gt_u32 vcc, 4, v2
    s_nop 3
    s_cbranch_vccnz L_cons6
    s_cmp_lg_u32 s75, 0
    s_cbranch_scc1 L_nofl3
L_af:
    ds_read_b32 v2, v12 offset:116
    s_waitcnt lgkmcnt(0)
    v_cmp_gt_u32 vcc, 4, v2
    s_nop 3
    s_cbranch_vccnz L_af
    buffer_store_dword v14, v13, s[24:27], s76 offen sc1
    s_mov_b32 s75, 1
L_nofl3:
    s_add_u32 m0, s53, 21504
    s_add_u32 s43, s3, 6
    s_cmp_ge_u32 s43, 7
    s_cselect_b32 s62, 7, 0
    s_sub_u32 s43, s43, s62
    s_mul_i32 s43, s43, 229376
    s_add_u32 s43, s43, s54
    buffer_load_dwordx4 v208, s[32:35], s43 offen offset:0 lds
    buffer_load_dwordx4 v209, s[32:35], s43 offen offset:1024 lds
    s_waitcnt vmcnt(9)
    s_mov_b64 exec, 1
    ds_add_u32 v12, v14 offset:16
    s_mov_b64 exec, -1
    buffer_load_dwordx4 v210, s[32:35], s43 offen offset:2048 lds
    buffer_load_dwordx4 v211, s[32:35], s43 offen offset:3072 lds
    s_add_u32 m0, s53, 25600
    s_nop 0
    buffer_load_dwordx4 v212, s[32:35], s43 offen offset:0 lds
    buffer_load_dwordx4 v213, s[32:35], s43 offen offset:1024 lds
    buffer_load_dwordx4 v214, s[32:35], s43 offen offset:2048 lds
    s_waitcnt vmcnt(7)
    s_mov_b64 exec, 1
    ds_add_u32 v12, v14 offset:20
    s_mov_b64 exec, -1
    s_waitcnt vmcnt(0)
    s_mov_b64 exec, 1
    ds_add_u32 v12, v14 offset:24
    s_mov_b64 exec, -1
    s_mov_b32 s62, 0
L_p1:
    buffer_load_dword v2, v1, s[24:27], s68 offen sc1
    s_add_u32 s62, s62, 1
    s_waitcnt vmcnt(0)
    v_cmp_le_u32 vcc, 1, v2
    s_cmp_gt_u32 s62, 65536
    s_cbranch_scc1 L_p1_x
    s_nop 1
    s_cmp_eq_u64 vcc, -1
    s_cbranch_scc1 L_p1_x
    s_sleep 4
    s_branch L_p1
L_p1_x:
    buffer_load_dwordx4 v[224:227], v15, s[24:27], s9 offen offset:0 sc1
    buffer_load_dwordx4 v[228:231], v15, s[24:27], s9 offen offset:1024 sc1
    buffer_load_dwordx4 v[232:235], v15, s[24:27], s10 offen offset:0 sc1
    buffer_load_dwordx4 v[236:239], v15, s[24:27], s10 offen offset:1024 sc1
    buffer_load_dwordx4 v[240:243], v15, s[24:27], s11 offen offset:0 sc1
    buffer_load_dwordx4 v[244:247], v15, s[24:27], s11 offen offset:1024 sc1
    buffer_load_dwordx4 v[248:251], v15, s[24:27], s8 offen offset:0 sc1
    buffer_load_dwordx4 v[252:255], v15, s[24:27], s8 offen offset:1024 sc1
    buffer_load_dwordx4 v[128:131], v15, s[4:7], s69 offen offset:0 sc1
    buffer_load_dwordx4 v[132:135], v15, s[4:7], s69 offen offset:1024 sc1
    buffer_load_dwordx4 v[136:139], v15, s[4:7], s69 offen offset:2048 sc1
    buffer_load_dwordx4 v[140:143], v15, s[4:7], s69 offen offset:3072 sc1
    s_add_u32 s69, s69, 4096
    s_and_b32 s69, s69, 0xffff
    buffer_load_dwordx4 v[144:147], v15, s[4:7], s69 offen offset:0 sc1
    buffer_load_dwordx4 v[148:151], v15, s[4:7], s69 offen offset:1024 sc1
    buffer_load_dwordx4 v[152:155], v15, s[4:7], s69 offen offset:2048 sc1
    buffer_load_dwordx4 v[156:159], v15, s[4:7], s69 offen offset:3072 sc1
    s_add_u32 s69, s69, 4096
    s_and_b32 s69, s69, 0xffff
    buffer_load_dwordx4 v[160:163], v15, s[4:7], s69 offen offset:0 sc1
    buffer_load_dwordx4 v[164:167], v15, s[4:7], s69 offen offset:1024 sc1
    buffer_load_dwordx4 v[168:171], v15, s[4:7], s69 offen offset:2048 sc1
    buffer_load_dwordx4 v[172:175], v15, s[4:7], s69 offen offset:3072 sc1
    s_add_u32 s69, s69, 4096
    s_and_b32 s69, s69, 0xffff
    v_min_u32 v6, 12, v0
    v_lshlrev_b32 v6, 7, v6
    s_lshl_b32 s51, s2, 2
    s_add_u32 s51, s51, s44
    s_mul_i32 s62, s51, 1568
    buffer_load_dword v221, v6, s[36:39], s62 offen
    v_min_u32 v7, 3, v0
    v_lshlrev_b32 v7, 7, v7
    s_mul_i32 s62, s51, 392
    buffer_load_dword v221, v7, s[16:19], s62 offen
    s_setprio 0
    s_waitcnt vmcnt(10)
    s_mov_b64 exec, 1
    ds_add_u32 v12, v14 offset:52
    s_mov_b64 exec, -1
    v_mfma_f32_32x32x16_bf16 v[80:95], v[128:131], v[224:227], 0
    v_mfma_f32_32x32x16_bf16 v[80:95], v[132:135], v[228:231], v[80:95]
    s_nop 7
    s_nop 3
.p2align 3
L_att:
    v_mfma_f32_32x32x16_bf16 v[96:111], v[128:131], v[232:235], 0
    buffer_load_dwordx4 v[176:179], v15, s[4:7], s69 offen offset:0 sc1
    v_exp_f32 v80, v80
    v_exp_f32 v81, v81
    v_exp_f32 v82, v82
    v_exp_f32 v83, v83
    v_cvt_pk_bf16_f32 v192, v80, v81
    v_cvt_pk_bf16_f32 v193, v82, v83
    v_mfma_f32_32x32x16_bf16 v[96:111], v[132:135], v[236:239], v[96:111]
    v_exp_f32 v84, v84
    v_exp_f32 v85, v85
    v_exp_f32 v86, v86
    v_exp_f32 v87, v87
    v_cvt_pk_bf16_f32 v194, v84, v85
    v_cvt_pk_bf16_f32 v195, v86, v87
    v_mfma_f32_32x32x16_bf16 v[16:31], v[188:191], v[196:199], v[16:31]
    s_waitcnt vmcnt(9)
    v_exp_f32 v88, v88
    v_exp_f32_e64 v89, v89
    v_exp_f32 v90, v90
    v_exp_f32 v91, v91
    v_cvt_pk_bf16_f32 v196, v88, v89
    v_cvt_pk_bf16_f32 v197, v90, v91
    v_mfma_f32_32x32x16_bf16 v[32:47], v[136:139], v[192:195], v[32:47]
    v_exp_f32 v92, v92
    v_exp_f32 v93, v93
    v_exp_f32 v94, v94
    v_exp_f32 v95, v95
    v_cvt_pk_bf16_f32 v198, v92, v93
    v_cvt_pk_bf16_f32 v199, v94, v95
    v_mfma_f32_32x32x16_bf16 v[80:95], v[128:131], v[240:243], 0
    buffer_load_dwordx4 v[180:183], v15, s[4:7], s69 offen offset:1024 sc1
    v_exp_f32 v96, v96
    v_exp_f32 v97, v97
    v_exp_f32 v98, v98
    v_exp_f32 v99, v99
    v_cvt_pk_bf16_f32 v192, v96, v97
    v_cvt_pk_bf16_f32 v193, v98, v99
    v_mfma_f32_32x32x16_bf16 v[80:95], v[132:135], v[244:247], v[80:95]
    v_exp_f32 v100, v100
    v_exp_f32 v101, v101
    v_exp_f32 v102, v102
    v_exp_f32 v103, v103
    v_cvt_pk_bf16_f32 v194, v100, v101
    v_cvt_pk_bf16_f32 v195, v102, v103
    v_mfma_f32_32x32x16_bf16 v[32:47], v[140:143], v[196:199], v[32:47]
    v_exp_f32 v104, v104
    v_exp_f32 v105, v105
    v_exp_f32 v106, v106
    v_exp_f32 v107, v107
    v_cvt_pk_bf16_f32 v196, v104, v105
    v_cvt_pk_bf16_f32 v197, v106, v107
    v_mfma_f32_32x32x16_bf16 v[48:63], v[136:139], v[192:195], v[48:63]
    v_exp_f32 v108, v108
    v_exp_f32 v109, v109
    v_exp_f32 v110, v110
    v_exp_f32 v111, v111
    v_cvt_pk_bf16_f32 v198, v108, v109
    v_cvt_pk_bf16_f32 v199, v110, v111
    v_mfma_f32_32x32x16_bf16 v[96:111], v[128:131], v[248:251], 0
    buffer_load_dwordx4 v[184:187], v15, s[4:7], s69 offen offset:2048 sc1
    v_exp_f32 v80, v80
    v_exp_f32 v81, v81
    v_exp_f32 v82, v82
    v_exp_f32 v83, v83
    v_cvt_pk_bf16_f32 v192, v80, v81
    v_cvt_pk_bf16_f32 v193, v82, v83
    v_mfma_f32_32x32x16_bf16 v[96:111], v[132:135], v[252:255], v[96:111]
    v_exp_f32 v84, v84
    v_exp_f32 v85, v85
    v_exp_f32 v86, v86
    v_exp_f32 v87, v87
    v_cvt_pk_bf16_f32 v194, v84, v85
    v_cvt_pk_bf16_f32 v195, v86, v87
    v_mfma_f32_32x32x16_bf16 v[48:63], v[140:143], v[196:199], v[48:63]
    s_add_u32 s55, s55, 1
    v_exp_f32 v88, v88
    v_exp_f32_e64 v89, v89
    v_exp_f32 v90, v90
    v_exp_f32 v91, v91
    v_cvt_pk_bf16_f32 v196, v88, v89
    v_cvt_pk_bf16_f32 v197, v90, v91
    v_mfma_f32_32x32x16_bf16 v[64:79], v[136:139], v[192:195], v[64:79]
    s_waitcnt vmcnt(9)
    v_exp_f32 v92, v92
    v_exp_f32_e64 v93, v93
    v_exp_f32 v94, v94
    v_exp_f32 v95, v95
    v_cvt_pk_bf16_f32 v198, v92, v93
    v_cvt_pk_bf16_f32 v199, v94, v95
    v_mfma_f32_32x32x16_bf16 v[80:95], v[144:147], v[224:227], 0
    buffer_load_dwordx4 v[188:191], v15, s[4:7], s69 offen offset:3072 sc1
    v_exp_f32 v96, v96
    v_exp_f32 v97, v97
    v_exp_f32 v98, v98
    v_exp_f32 v99, v99
    v_cvt_pk_bf16_f32 v192, v96, v97
    v_cvt_pk_bf16_f32 v193, v98, v99
    v_mfma_f32_32x32x16_bf16 v[80:95], v[148:151], v[228:231], v[80:95]
    s_add_u32 s69, s69, 4096
    v_exp_f32 v100, v100
    v_exp_f32 v101, v101
    v_exp_f32 v102, v102
    v_exp_f32 v103, v103
    v_cvt_pk_bf16_f32 v194, v100, v101
    v_cvt_pk_bf16_f32 v195, v102, v103
    v_mfma_f32_32x32x16_bf16 v[64:79], v[140:143], v[196:199], v[64:79]
    s_and_b32 s69, s69, 0xffff
    v_exp_f32 v104, v104
    v_exp_f32 v105, v105
    v_exp_f32 v106, v106
    v_exp_f32 v107, v107
    v_cvt_pk_bf16_f32 v196, v104, v105
    v_cvt_pk_bf16_f32 v197, v106, v107
    v_mfma_f32_32x32x16_bf16 v[16:31], v[136:139], v[192:195], v[16:31]
    s_cmp_eq_u32 s55, 4
    s_cselect_b32 s6, 0, s6
    v_exp_f32 v108, v108
    v_exp_f32 v109, v109
    v_exp_f32 v110, v110
    v_exp_f32 v111, v111
    v_cvt_pk_bf16_f32 v198, v108, v109
    v_cvt_pk_bf16_f32 v199, v110, v111
    v_mfma_f32_32x32x16_bf16 v[96:111], v[144:147], v[232:235], 0
    buffer_load_dwordx4 v[128:131], v15, s[4:7], s69 offen offset:0 sc1
    v_exp_f32 v80, v80
    v_exp_f32 v81, v81
    v_exp_f32 v82, v82
    v_exp_f32 v83, v83
    v_cvt_pk_bf16_f32 v192, v80, v81
    v_cvt_pk_bf16_f32 v193, v82, v83
    v_mfma_f32_32x32x16_bf16 v[96:111], v[148:151], v[236:239], v[96:111]
    v_exp_f32 v84, v84
    v_exp_f32 v85, v85
    v_exp_f32 v86, v86
    v_exp_f32 v87, v87
    v_cvt_pk_bf16_f32 v194, v84, v85
    v_cvt_pk_bf16_f32 v195, v86, v87
    v_mfma_f32_32x32x16_bf16 v[16:31], v[140:143], v[196:199], v[16:31]
    s_waitcnt vmcnt(9)
    v_exp_f32 v88, v88
    v_exp_f32_e64 v89, v89
    v_exp_f32 v90, v90
    v_exp_f32 v91, v91
    v_cvt_pk_bf16_f32 v196, v88, v89
    v_cvt_pk_bf16_f32 v197, v90, v91
    v_mfma_f32_32x32x16_bf16 v[32:47], v[152:155], v[192:195], v[32:47]
    v_exp_f32 v92, v92
    v_exp_f32 v93, v93
    v_exp_f32 v94, v94
    v_exp_f32 v95, v95
    v_cvt_pk_bf16_f32 v198, v92, v93
    v_cvt_pk_bf16_f32 v199, v94, v95
    v_mfma_f32_32x32x16_bf16 v[80:95], v[144:147], v[240:243], 0
    buffer_load_dwordx4 v[132:135], v15, s[4:7], s69 offen offset:1024 sc1
    v_exp_f32 v96, v96
    v_exp_f32 v97, v97
    v_exp_f32 v98, v98
    v_exp_f32 v99, v99
    v_cvt_pk_bf16_f32 v192, v96, v97
    v_cvt_pk_bf16_f32 v193, v98, v99
    v_mfma_f32_32x32x16_bf16 v[80:95], v[148:151], v[244:247], v[80:95]
    v_exp_f32 v100, v100
    v_exp_f32 v101, v101
    v_exp_f32 v102, v102
    v_exp_f32 v103, v103
    v_cvt_pk_bf16_f32 v194, v100, v101
    v_cvt_pk_bf16_f32 v195, v102, v103
    v_mfma_f32_32x32x16_bf16 v[32:47], v[156:159], v[196:199], v[32:47]
    v_exp_f32 v104, v104
    v_exp_f32 v105, v105
    v_exp_f32 v106, v106
    v_exp_f32 v107, v107
    v_cvt_pk_bf16_f32 v196, v104, v105
    v_cvt_pk_bf16_f32 v197, v106, v107
    v_mfma_f32_32x32x16_bf16 v[48:63], v[152:155], v[192:195], v[48:63]
    v_exp_f32 v108, v108
    v_exp_f32 v109, v109
    v_exp_f32 v110, v110
    v_exp_f32 v111, v111
    v_cvt_pk_bf16_f32 v198, v108, v109
    v_cvt_pk_bf16_f32 v199, v110, v111
    v_mfma_f32_32x32x16_bf16 v[96:111], v[144:147], v[248:251], 0
    buffer_load_dwordx4 v[136:139], v15, s[4:7], s69 offen offset:2048 sc1
    v_exp_f32 v80, v80
    v_exp_f32 v81, v81
    v_exp_f32 v82, v82
    v_exp_f32 v83, v83
    v_cvt_pk_bf16_f32 v192, v80, v81
    v_cvt_pk_bf16_f32 v193, v82, v83
    v_mfma_f32_32x32x16_bf16 v[96:111], v[148:151], v[252:255], v[96:111]
    v_exp_f32 v84, v84
    v_exp_f32 v85, v85
    v_exp_f32 v86, v86
    v_exp_f32 v87, v87
    v_cvt_pk_bf16_f32 v194, v84, v85
    v_cvt_pk_bf16_f32 v195, v86, v87
    v_mfma_f32_32x32x16_bf16 v[48:63], v[156:159], v[196:199], v[48:63]
    v_exp_f32 v88, v88
    v_exp_f32 v89, v89
    v_exp_f32 v90, v90
    v_exp_f32 v91, v91
    v_cvt_pk_bf16_f32 v196, v88, v89
    v_cvt_pk_bf16_f32 v197, v90, v91
    v_mfma_f32_32x32x16_bf16 v[64:79], v[152:155], v[192:195], v[64:79]
    s_waitcnt vmcnt(9)
    v_exp_f32 v92, v92
    v_exp_f32_e64 v93, v93
    v_exp_f32 v94, v94
    v_exp_f32 v95, v95
    v_cvt_pk_bf16_f32 v198, v92, v93
    v_cvt_pk_bf16_f32 v199, v94, v95
    v_mfma_f32_32x32x16_bf16 v[80:95], v[160:163], v[224:227], 0
    buffer_load_dwordx4 v[140:143], v15, s[4:7], s69 offen offset:3072 sc1
    v_exp_f32 v96, v96
    v_exp_f32 v97, v97
    v_exp_f32 v98, v98
    v_exp_f32 v99, v99
    v_cvt_pk_bf16_f32 v192, v96, v97
    v_cvt_pk_bf16_f32 v193, v98, v99
    v_mfma_f32_32x32x16_bf16 v[80:95], v[164:167], v[228:231], v[80:95]
    s_add_u32 s69, s69, 4096
    v_exp_f32 v100, v100
    v_exp_f32 v101, v101
    v_exp_f32 v102, v102
    v_exp_f32 v103, v103
    v_cvt_pk_bf16_f32 v194, v100, v101
    v_cvt_pk_bf16_f32 v195, v102, v103
    v_mfma_f32_32x32x16_bf16 v[64:79], v[156:159], v[196:199], v[64:79]
    s_and_b32 s69, s69, 0xffff
    v_exp_f32 v104, v104
    v_exp_f32 v105, v105
    v_exp_f32 v106, v106
    v_exp_f32 v107, v107
    v_cvt_pk_bf16_f32 v196, v104, v105
    v_cvt_pk_bf16_f32 v197, v106, v107
    v_mfma_f32_32x32x16_bf16 v[16:31], v[152:155], v[192:195], v[16:31]
    v_exp_f32 v108, v108
    v_exp_f32 v109, v109
    v_exp_f32 v110, v110
    v_exp_f32 v111, v111
    v_cvt_pk_bf16_f32 v198, v108, v109
    v_cvt_pk_bf16_f32 v199, v110, v111
    v_mfma_f32_32x32x16_bf16 v[96:111], v[160:163], v[232:235], 0
    buffer_load_dwordx4 v[144:147], v15, s[4:7], s69 offen offset:0 sc1
    v_exp_f32 v80, v80
    v_exp_f32 v81, v81
    v_exp_f32 v82, v82
    v_exp_f32 v83, v83
    v_cvt_pk_bf16_f32 v192, v80, v81
    v_cvt_pk_bf16_f32 v193, v82, v83
    v_mfma_f32_32x32x16_bf16 v[96:111], v[164:167], v[236:239], v[96:111]
    v_exp_f32 v84, v84
    v_exp_f32 v85, v85
    v_exp_f32 v86, v86
    v_exp_f32 v87, v87
    v_cvt_pk_bf16_f32 v194, v84, v85
    v_cvt_pk_bf16_f32 v195, v86, v87
    v_mfma_f32_32x32x16_bf16 v[16:31], v[156:159], v[196:199], v[16:31]
    s_waitcnt vmcnt(9)
    v_exp_f32 v88, v88
    v_exp_f32_e64 v89, v89
    v_exp_f32 v90, v90
    v_exp_f32 v91, v91
    v_cvt_pk_bf16_f32 v196, v88, v89
    v_cvt_pk_bf16_f32 v197, v90, v91
    v_mfma_f32_32x32x16_bf16 v[32:47], v[168:171], v[192:195], v[32:47]
    v_exp_f32 v92, v92
    v_exp_f32 v93, v93
    v_exp_f32 v94, v94
    v_exp_f32 v95, v95
    v_cvt_pk_bf16_f32 v198, v92, v93
    v_cvt_pk_bf16_f32 v199, v94, v95
    v_mfma_f32_32x32x16_bf16 v[80:95], v[160:163], v[240:243], 0
    buffer_load_dwordx4 v[148:151], v15, s[4:7], s69 offen offset:1024 sc1
    v_exp_f32 v96, v96
    v_exp_f32 v97, v97
    v_exp_f32 v98, v98
    v_exp_f32 v99, v99
    v_cvt_pk_bf16_f32 v192, v96, v97
    v_cvt_pk_bf16_f32 v193, v98, v99
    v_mfma_f32_32x32x16_bf16 v[80:95], v[164:167], v[244:247], v[80:95]
    v_exp_f32 v100, v100
    v_exp_f32 v101, v101
    v_exp_f32 v102, v102
    v_exp_f32 v103, v103
    v_cvt_pk_bf16_f32 v194, v100, v101
    v_cvt_pk_bf16_f32 v195, v102, v103
    v_mfma_f32_32x32x16_bf16 v[32:47], v[172:175], v[196:199], v[32:47]
    v_exp_f32 v104, v104
    v_exp_f32 v105, v105
    v_exp_f32 v106, v106
    v_exp_f32 v107, v107
    v_cvt_pk_bf16_f32 v196, v104, v105
    v_cvt_pk_bf16_f32 v197, v106, v107
    v_mfma_f32_32x32x16_bf16 v[48:63], v[168:171], v[192:195], v[48:63]
    v_exp_f32 v108, v108
    v_exp_f32 v109, v109
    v_exp_f32 v110, v110
    v_exp_f32 v111, v111
    v_cvt_pk_bf16_f32 v198, v108, v109
    v_cvt_pk_bf16_f32 v199, v110, v111
    v_mfma_f32_32x32x16_bf16 v[96:111], v[160:163], v[248:251], 0
    buffer_load_dwordx4 v[152:155], v15, s[4:7], s69 offen offset:2048 sc1
    v_exp_f32 v80, v80
    v_exp_f32 v81, v81
    v_exp_f32 v82, v82
    v_exp_f32 v83, v83
    v_cvt_pk_bf16_f32 v192, v80, v81
    v_cvt_pk_bf16_f32 v193, v82, v83
    v_mfma_f32_32x32x16_bf16 v[96:111], v[164:167], v[252:255], v[96:111]
    v_exp_f32 v84, v84
    v_exp_f32 v85, v85
    v_exp_f32 v86, v86
    v_exp_f32 v87, v87
    v_cvt_pk_bf16_f32 v194, v84, v85
    v_cvt_pk_bf16_f32 v195, v86, v87
    v_mfma_f32_32x32x16_bf16 v[48:63], v[172:175], v[196:199], v[48:63]
    v_exp_f32 v88, v88
    v_exp_f32 v89, v89
    v_exp_f32 v90, v90
    v_exp_f32 v91, v91
    v_cvt_pk_bf16_f32 v196, v88, v89
    v_cvt_pk_bf16_f32 v197, v90, v91
    v_mfma_f32_32x32x16_bf16 v[64:79], v[168:171], v[192:195], v[64:79]
    s_waitcnt vmcnt(9)
    v_exp_f32 v92, v92
    v_exp_f32_e64 v93, v93
    v_exp_f32 v94, v94
    v_exp_f32 v95, v95
    v_cvt_pk_bf16_f32 v198, v92, v93
    v_cvt_pk_bf16_f32 v199, v94, v95
    v_mfma_f32_32x32x16_bf16 v[80:95], v[176:179], v[224:227], 0
    buffer_load_dwordx4 v[156:159], v15, s[4:7], s69 offen offset:3072 sc1
    v_exp_f32 v96, v96
    v_exp_f32 v97, v97
    v_exp_f32 v98, v98
    v_exp_f32 v99, v99
    v_cvt_pk_bf16_f32 v192, v96, v97
    v_cvt_pk_bf16_f32 v193, v98, v99
    v_mfma_f32_32x32x16_bf16 v[80:95], v[180:183], v[228:231], v[80:95]
    s_add_u32 s69, s69, 4096
    v_exp_f32 v100, v100
    v_exp_f32 v101, v101
    v_exp_f32 v102, v102
    v_exp_f32 v103, v103
    v_cvt_pk_bf16_f32 v194, v100, v101
    v_cvt_pk_bf16_f32 v195, v102, v103
    v_mfma_f32_32x32x16_bf16 v[64:79], v[172:175], v[196:199], v[64:79]
    s_and_b32 s69, s69, 0xffff
    v_exp_f32 v104, v104
    v_exp_f32 v105, v105
    v_exp_f32 v106, v106
    v_exp_f32 v107, v107
    v_cvt_pk_bf16_f32 v196, v104, v105
    v_cvt_pk_bf16_f32 v197, v106, v107
    v_mfma_f32_32x32x16_bf16 v[16:31], v[168:171], v[192:195], v[16:31]
    s_cmp_eq_u32 s55, 4
    v_exp_f32 v108, v108
    v_exp_f32_e64 v109, v109
    v_exp_f32 v110, v110
    v_exp_f32 v111, v111
    v_cvt_pk_bf16_f32 v198, v108, v109
    v_cvt_pk_bf16_f32 v199, v110, v111
    v_mfma_f32_32x32x16_bf16 v[96:111], v[176:179], v[232:235], 0
    s_cbranch_scc1 L_last
    s_nop 0
    buffer_load_dwordx4 v[160:163], v15, s[4:7], s69 offen offset:0 sc1
    v_exp_f32 v80, v80
    v_exp_f32 v81, v81
    v_exp_f32 v82, v82
    v_exp_f32 v83, v83
    v_cvt_pk_bf16_f32 v192, v80, v81
    v_cvt_pk_bf16_f32 v193, v82, v83
    v_mfma_f32_32x32x16_bf16 v[96:111], v[180:183], v[236:239], v[96:111]
    v_exp_f32 v84, v84
    v_exp_f32 v85, v85
    v_exp_f32 v86, v86
    v_exp_f32 v87, v87
    v_cvt_pk_bf16_f32 v194, v84, v85
    v_cvt_pk_bf16_f32 v195, v86, v87
    v_mfma_f32_32x32x16_bf16 v[16:31], v[172:175], v[196:199], v[16:31]
    s_waitcnt vmcnt(9)
    v_exp_f32 v88, v88
    v_exp_f32_e64 v89, v89
    v_exp_f32 v90, v90
    v_exp_f32 v91, v91
    v_cvt_pk_bf16_f32 v196, v88, v89
    v_cvt_pk_bf16_f32 v197, v90, v91
    v_mfma_f32_32x32x16_bf16 v[32:47], v[184:187], v[192:195], v[32:47]
    v_exp_f32 v92, v92
    v_exp_f32 v93, v93
    v_exp_f32 v94, v94
    v_exp_f32 v95, v95
    v_cvt_pk_bf16_f32 v198, v92, v93
    v_cvt_pk_bf16_f32 v199, v94, v95
    v_mfma_f32_32x32x16_bf16 v[80:95], v[176:179], v[240:243], 0
    buffer_load_dwordx4 v[164:167], v15, s[4:7], s69 offen offset:1024 sc1
    v_exp_f32 v96, v96
    v_exp_f32 v97, v97
    v_exp_f32 v98, v98
    v_exp_f32 v99, v99
    v_cvt_pk_bf16_f32 v192, v96, v97
    v_cvt_pk_bf16_f32 v193, v98, v99
    v_mfma_f32_32x32x16_bf16 v[80:95], v[180:183], v[244:247], v[80:95]
    v_exp_f32 v100, v100
    v_exp_f32 v101, v101
    v_exp_f32 v102, v102
    v_exp_f32 v103, v103
    v_cvt_pk_bf16_f32 v194, v100, v101
    v_cvt_pk_bf16_f32 v195, v102, v103
    v_mfma_f32_32x32x16_bf16 v[32:47], v[188:191], v[196:199], v[32:47]
    v_exp_f32 v104, v104
    v_exp_f32 v105, v105
    v_exp_f32 v106, v106
    v_exp_f32 v107, v107
    v_cvt_pk_bf16_f32 v196, v104, v105
    v_cvt_pk_bf16_f32 v197, v106, v107
    v_mfma_f32_32x32x16_bf16 v[48:63], v[184:187], v[192:195], v[48:63]
    v_exp_f32 v108, v108
    v_exp_f32 v109, v109
    v_exp_f32 v110, v110
    v_exp_f32 v111, v111
    v_cvt_pk_bf16_f32 v198, v108, v109
    v_cvt_pk_bf16_f32 v199, v110, v111
    v_mfma_f32_32x32x16_bf16 v[96:111], v[176:179], v[248:251], 0
    buffer_load_dwordx4 v[168:171], v15, s[4:7], s69 offen offset:2048 sc1
    v_exp_f32 v80, v80
    v_exp_f32 v81, v81
    v_exp_f32 v82, v82
    v_exp_f32 v83, v83
    v_cvt_pk_bf16_f32 v192, v80, v81
    v_cvt_pk_bf16_f32 v193, v82, v83
    v_mfma_f32_32x32x16_bf16 v[96:111], v[180:183], v[252:255], v[96:111]
    v_exp_f32 v84, v84
    v_exp_f32 v85, v85
    v_exp_f32 v86, v86
    v_exp_f32 v87, v87
    v_cvt_pk_bf16_f32 v194, v84, v85
    v_cvt_pk_bf16_f32 v195, v86, v87
    v_mfma_f32_32x32x16_bf16 v[48:63], v[188:191], v[196:199], v[48:63]
    v_exp_f32 v88, v88
    v_exp_f32 v89, v89
    v_exp_f32 v90, v90
    v_exp_f32 v91, v91
    v_cvt_pk_bf16_f32 v196, v88, v89
    v_cvt_pk_bf16_f32 v197, v90, v91
    v_mfma_f32_32x32x16_bf16 v[64:79], v[184:187], v[192:195], v[64:79]
    s_waitcnt vmcnt(9)
    v_exp_f32 v92, v92
    v_exp_f32_e64 v93, v93
    v_exp_f32 v94, v94
    v_exp_f32 v95, v95
    v_cvt_pk_bf16_f32 v198, v92, v93
    v_cvt_pk_bf16_f32 v199, v94, v95
    v_mfma_f32_32x32x16_bf16 v[80:95], v[128:131], v[224:227], 0
    buffer_load_dwordx4 v[172:175], v15, s[4:7], s69 offen offset:3072 sc1
    v_exp_f32 v96, v96
    v_exp_f32 v97, v97
    v_exp_f32 v98, v98
    v_exp_f32 v99, v99
    v_cvt_pk_bf16_f32 v192, v96, v97
    v_cvt_pk_bf16_f32 v193, v98, v99
    v_mfma_f32_32x32x16_bf16 v[80:95], v[132:135], v[228:231], v[80:95]
    s_add_u32 s69, s69, 4096
    v_exp_f32 v100, v100
    v_exp_f32 v101, v101
    v_exp_f32 v102, v102
    v_exp_f32 v103, v103
    v_cvt_pk_bf16_f32 v194, v100, v101
    v_cvt_pk_bf16_f32 v195, v102, v103
    v_mfma_f32_32x32x16_bf16 v[64:79], v[188:191], v[196:199], v[64:79]
    s_and_b32 s69, s69, 0xffff
    v_exp_f32 v104, v104
    v_exp_f32 v105, v105
    v_exp_f32 v106, v106
    v_exp_f32 v107, v107
    v_cvt_pk_bf16_f32 v196, v104, v105
    v_cvt_pk_bf16_f32 v197, v106, v107
    v_mfma_f32_32x32x16_bf16 v[16:31], v[184:187], v[192:195], v[16:31]
    v_exp_f32 v108, v108
    v_exp_f32 v109, v109
    v_exp_f32 v110, v110
    v_exp_f32 v111, v111
    v_cvt_pk_bf16_f32 v198, v108, v109
    v_cvt_pk_bf16_f32 v199, v110, v111
    s_branch L_att
.p2align 3
L_last:
    ds_read_b32 v200, v12 offset:100
    v_exp_f32 v80, v80
    v_exp_f32 v81, v81
    v_exp_f32 v82, v82
    v_exp_f32 v83, v83
    v_cvt_pk_bf16_f32 v192, v80, v81
    v_cvt_pk_bf16_f32 v193, v82, v83
    v_mfma_f32_32x32x16_bf16 v[96:111], v[180:183], v[236:239], v[96:111]
    v_exp_f32 v84, v84
    v_exp_f32 v85, v85
    v_exp_f32 v86, v86
    v_exp_f32 v87, v87
    v_cvt_pk_bf16_f32 v194, v84, v85
    v_cvt_pk_bf16_f32 v195, v86, v87
    v_mfma_f32_32x32x16_bf16 v[16:31], v[172:175], v[196:199], v[16:31]
    s_waitcnt vmcnt(8) lgkmcnt(0)
    v_cmp_gt_u32 vcc, 4, v200
    v_exp_f32 v88, v88
    v_exp_f32 v89, v89
    v_exp_f32 v90, v90
    v_exp_f32 v91, v91
    v_cvt_pk_bf16_f32 v196, v88, v89
    v_cvt_pk_bf16_f32 v197, v90, v91
    v_mfma_f32_32x32x16_bf16 v[32:47], v[184:187], v[192:195], v[32:47]
    v_exp_f32 v92, v92
    v_exp_f32 v93, v93
    v_exp_f32 v94, v94
    v_exp_f32 v95, v95
    v_cvt_pk_bf16_f32 v198, v92, v93
    v_cvt_pk_bf16_f32 v199, v94, v95
    v_mfma_f32_32x32x16_bf16 v[80:95], v[176:179], v[240:243], 0
    s_cbranch_vccnz L_hd
L_hd_x:
    v_exp_f32 v96, v96
    v_exp_f32_e64 v97, v97
    v_exp_f32 v98, v98
    v_exp_f32 v99, v99
    v_cvt_pk_bf16_f32 v192, v96, v97
    v_cvt_pk_bf16_f32 v193, v98, v99
    v_mfma_f32_32x32x16_bf16 v[80:95], v[180:183], v[244:247], v[80:95]
    s_mov_b32 s42, 0x1f800000
    v_exp_f32 v100, v100
    v_exp_f32 v101, v101
    v_exp_f32 v102, v102
    v_exp_f32 v103, v103
    v_cvt_pk_bf16_f32 v194, v100, v101
    v_cvt_pk_bf16_f32 v195, v102, v103
    v_mfma_f32_32x32x16_bf16 v[32:47], v[188:191], v[196:199], v[32:47]
    s_mov_b32 s43, 0x5f800000
    v_exp_f32 v104, v104
    v_exp_f32 v105, v105
    v_exp_f32 v106, v106
    v_exp_f32 v107, v107
    v_cvt_pk_bf16_f32 v196, v104, v105
    v_cvt_pk_bf16_f32 v197, v106, v107
    v_mfma_f32_32x32x16_bf16 v[48:63], v[184:187], v[192:195], v[48:63]
    v_exp_f32 v108, v108
    v_exp_f32 v109, v109
    v_exp_f32 v110, v110
    v_exp_f32 v111, v111
    v_cvt_pk_bf16_f32 v198, v108, v109
    v_cvt_pk_bf16_f32 v199, v110, v111
    v_mfma_f32_32x32x16_bf16 v[96:111], v[176:179], v[248:251], 0
    ds_write_b128 v205, v[32:35] offset:0
    v_exp_f32 v80, v80
    v_exp_f32 v81, v81
    v_exp_f32 v82, v82
    v_exp_f32 v83, v83
    v_cvt_pk_bf16_f32 v192, v80, v81
    v_cvt_pk_bf16_f32 v193, v82, v83
    v_mfma_f32_32x32x16_bf16 v[96:111], v[180:183], v[252:255], v[96:111]
    ds_write_b128 v205, v[36:39] offset:1024
    v_exp_f32 v84, v84
    v_exp_f32 v85, v85
    v_exp_f32 v86, v86
    v_exp_f32 v87, v87
    v_cvt_pk_bf16_f32 v194, v84, v85
    v_cvt_pk_bf16_f32 v195, v86, v87
    v_mfma_f32_32x32x16_bf16 v[48:63], v[188:191], v[196:199], v[48:63]
    ds_write_b128 v205, v[40:43] offset:2048
    v_exp_f32 v88, v88
    v_exp_f32 v89, v89
    v_exp_f32 v90, v90
    v_exp_f32 v91, v91
    v_cvt_pk_bf16_f32 v196, v88, v89
    v_cvt_pk_bf16_f32 v197, v90, v91
    v_mfma_f32_32x32x16_bf16 v[64:79], v[184:187], v[192:195], v[64:79]
    ds_write_b128 v205, v[44:47] offset:3072
    v_exp_f32 v92, v92
    v_exp_f32 v93, v93
    v_exp_f32 v94, v94
    v_exp_f32 v95, v95
    v_cvt_pk_bf16_f32 v198, v92, v93
    v_cvt_pk_bf16_f32 v199, v94, v95
    ds_write_b128 v206, v[48:51] offset:4096
    ds_write_b128 v206, v[52:55] offset:5120
    v_mfma_f32_32x32x16_bf16 v[64:79], v[188:191], v[196:199], v[64:79]
    v_exp_f32 v96, v96
    v_exp_f32 v97, v97
    v_exp_f32 v98, v98
    v_exp_f32 v99, v99
    v_cvt_pk_bf16_f32 v192, v96, v97
    v_cvt_pk_bf16_f32 v193, v98, v99
    ds_write_b128 v206, v[56:59] offset:6144
    ds_write_b128 v206, v[60:63] offset:7168
    v_exp_f32 v100, v100
    v_exp_f32 v101, v101
    v_exp_f32 v102, v102
    v_exp_f32 v103, v103
    v_cvt_pk_bf16_f32 v194, v100, v101
    v_cvt_pk_bf16_f32 v195, v102, v103
    ds_write_b128 v207, v[64:67] offset:8192
    ds_write_b128 v207, v[68:71] offset:9216
    v_exp_f32 v104, v104
    v_exp_f32 v105, v105
    v_exp_f32 v106, v106
    v_exp_f32 v107, v107
    v_cvt_pk_bf16_f32 v196, v104, v105
    v_cvt_pk_bf16_f32 v197, v106, v107
    v_mfma_f32_32x32x16_bf16 v[16:31], v[184:187], v[192:195], v[16:31]
    ds_write_b128 v207, v[72:75] offset:10240
    ds_write_b128 v207, v[76:79] offset:11264
    v_exp_f32 v108, v108
    v_exp_f32 v109, v109
    v_exp_f32 v110, v110
    v_exp_f32 v111, v111
    v_cvt_pk_bf16_f32 v198, v108, v109
    v_cvt_pk_bf16_f32 v199, v110, v111
    s_setprio 2
    s_waitcnt lgkmcnt(0)
    v_mfma_f32_32x32x16_bf16 v[16:31], v[188:191], v[196:199], v[16:31]
    s_mov_b64 exec, 1
    ds_add_u32 v12, v14 offset:68
    s_mov_b64 exec, -1
L_cw:
    ds_read_b32 v200, v12 offset:68
    s_waitcnt lgkmcnt(0)
    v_cmp_gt_u32 vcc, 4, v200
    s_nop 3
    s_cbranch_vccnz L_cw
    ds_read_b128 v[44:47], v204 offset:3072
    ds_read_b128 v[60:63], v204 offset:7168
    ds_read_b128 v[76:79], v204 offset:11264
    ds_read_b128 v[32:35], v204 offset:0
    ds_read_b128 v[48:51], v204 offset:4096
    ds_read_b128 v[64:67], v204 offset:8192
    ds_read_b128 v[36:39], v204 offset:1024
    ds_read_b128 v[52:55], v204 offset:5120
    ds_read_b128 v[68:71], v204 offset:9216
    ds_read_b128 v[40:43], v204 offset:2048
    ds_read_b128 v[56:59], v204 offset:6144
    ds_read_b128 v[72:75], v204 offset:10240
    s_waitcnt lgkmcnt(9)
    v_add_f32 v28, v28, v44
    v_add_f32 v29, v29, v45
    v_add_f32 v30, v30, v46
    v_add_f32 v31, v31, v47
    v_add_f32 v60, v60, v76
    v_add_f32 v61, v61, v77
    v_add_f32 v62, v62, v78
    v_add_f32 v63, v63, v79
    v_add_f32 v28, v28, v60
    v_add_f32 v29, v29, v61
    v_add_f32 v30, v30, v62
    v_add_f32 v31, v31, v63
    v_mov_b32 v200, v28
    v_mov_b32 v201, v28
    s_waitcnt lgkmcnt(6)
    v_add_f32 v16, v16, v32
    v_add_f32 v17, v17, v33
    v_add_f32 v18, v18, v34
    v_add_f32 v19, v19, v35
    v_add_f32 v48, v48, v64
    v_add_f32 v49, v49, v65
    v_add_f32 v50, v50, v66
    v_add_f32 v51, v51, v67
    v_add_f32 v16, v16, v48
    v_add_f32 v17, v17, v49
    v_add_f32 v18, v18, v50
    v_add_f32 v19, v19, v51
    v_permlane32_swap_b32 v200, v201
    s_waitcnt lgkmcnt(3)
    v_add_f32 v20, v20, v36
    v_add_f32 v21, v21, v37
    v_add_f32 v22, v22, v38
    v_add_f32 v23, v23, v39
    v_add_f32 v52, v52, v68
    v_add_f32 v53, v53, v69
    v_add_f32 v54, v54, v70
    v_add_f32 v55, v55, v71
    v_add_f32 v20, v20, v52
    v_add_f32 v21, v21, v53
    v_add_f32_e64 v22, v22, v54
    v_add_f32 v23, v23, v55
    v_cmp_le_f32 vcc, s42, v201
    v_cmp_ge_f32 s[56:57], s43, v201
    v_rcp_f32 v200, v201
    s_waitcnt lgkmcnt(0)
    v_add_f32 v24, v24, v40
    v_add_f32 v25, v25, v41
    v_add_f32 v26, v26, v42
    v_add_f32 v27, v27, v43
    v_add_f32 v56, v56, v72
    v_add_f32 v57, v57, v73
    v_add_f32 v58, v58, v74
    v_add_f32 v59, v59, v75
    v_add_f32 v24, v24, v56
    v_add_f32 v25, v25, v57
    v_add_f32 v26, v26, v58
    v_add_f32 v27, v27, v59
    s_and_b64 vcc, vcc, s[56:57]
    s_cmp_eq_u64 vcc, -1
    s_cbranch_scc0 L_slow
L_fin:
    v_mul_f32 v16, v16, v200
    v_mul_f32 v17, v17, v200
    v_mul_f32 v18, v18, v200
    v_mul_f32 v19, v19, v200
    v_mul_f32 v20, v20, v200
    v_mul_f32 v21, v21, v200
    v_mul_f32 v22, v22, v200
    v_mul_f32_e64 v23, v23, v200
    v_cvt_pk_bf16_f32 v192, v16, v17
    v_cvt_pk_bf16_f32 v193, v18, v19
    v_cvt_pk_bf16_f32 v194, v20, v21
    v_cvt_pk_bf16_f32 v195, v22, v23
    buffer_store_dwordx4 v[192:195], v15, s[24:27], s67 offen sc1
    v_mul_f32 v24, v24, v200
    v_mul_f32 v25, v25, v200
    v_mul_f32 v26, v26, v200
    v_mul_f32 v27, v27, v200
    v_mul_f32 v28, v28, v200
    v_mul_f32 v29, v29, v200
    v_mul_f32 v30, v30, v200
    v_mul_f32 v31, v31, v200
    v_cvt_pk_bf16_f32 v196, v24, v25
    v_cvt_pk_bf16_f32 v197, v26, v27
    v_cvt_pk_bf16_f32 v198, v28, v29
    v_cvt_pk_bf16_f32 v199, v30, v31
    v_cndmask_b32 v198, v198, 0, s[40:41]
    v_cndmask_b32 v199, v199, 0, s[40:41]
    buffer_store_dwordx4 v[196:199], v15, s[24:27], s67 offen offset:1024 sc1
    v_mov_b32_e64 v13, 0
    s_waitcnt vmcnt(0)
    s_mov_b64 exec, 1
    ds_add_rtn_u32 v13, v12, v14 offset:124
    s_mov_b64 exec, -1
    s_waitcnt lgkmcnt(0)
    v_xor_b32 v13, 3, v13
    v_lshlrev_b32 v13, 25, v13
    buffer_store_dword v14, v13, s[24:27], s60 offen sc1
L_c_end:
L_end:
    s_endpgm
L_go:
    s_mov_b32 s62, 0
L_p0:
    buffer_load_dword v223, v222, s[12:15], 0 offen sc1
    s_add_u32 s62, s62, 1
    s_waitcnt vmcnt(0)
    v_cmp_le_u32_e64 vcc, 1, v223
    s_cmp_gt_u32 s62, 65536
    s_cbranch_scc1 L_p0_x
    s_nop 1
    s_cmp_eq_u64 vcc, -1
    s_cbranch_scc1 L_p0_x
    s_sleep 2
    s_branch L_p0
L_p0_x:
    s_branch L_go_x
L_hd:
    ds_read_b32 v200, v12 offset:100
    s_waitcnt lgkmcnt(0)
    v_cmp_gt_u32_e64 vcc, 4, v200
    s_nop 3
    s_cbranch_vccnz L_hd
    s_branch L_hd_x
L_slow:
    s_lshl_b32 s56, s65, 18
    s_add_u32 s56, s56, 2097152
    s_mov_b32 s57, s56
    s_mov_b32 s55, 64
    v_mov_b32 v202, 0xff800000
    s_waitcnt vmcnt(0)
L_slow1:
    buffer_load_dwordx4 v[128:131], v15, s[24:27], s57 offen offset:0 sc1
    buffer_load_dwordx4 v[132:135], v15, s[24:27], s57 offen offset:1024 sc1
    s_waitcnt vmcnt(0)
    v_mfma_f32_32x32x16_bf16 v[96:111], v[128:131], v[248:251], 0
    v_mfma_f32_32x32x16_bf16 v[96:111], v[132:135], v[252:255], v[96:111]
    s_nop 7
    s_nop 7
    v_max3_f32 v202, v96, v97, v202
    v_max3_f32 v202, v98, v99, v202
    v_max3_f32 v202, v100, v101, v202
    v_max3_f32 v202, v102, v103, v202
    v_max3_f32 v202, v104, v105, v202
    v_max3_f32 v202, v106, v107, v202
    v_max3_f32 v202, v108, v109, v202
    v_max3_f32 v202, v110, v111, v202
    s_add_u32 s57, s57, 4096
    s_sub_u32 s55, s55, 1
    s_cmp_lg_u32 s55, 0
    s_cbranch_scc1 L_slow1
    v_mov_b32 v203, v202
    s_nop 1
    v_permlane32_swap_b32 v203, v202
    s_nop 1
    v_max_f32 v202, v202, v203
    v_mov_b32 v16, 0
    v_mov_b32 v17, 0
    v_mov_b32 v18, 0
    v_mov_b32 v19, 0
    v_mov_b32 v20, 0
    v_mov_b32 v21, 0
    v_mov_b32 v22, 0
    v_mov_b32 v23, 0
    v_mov_b32 v24, 0
    v_mov_b32 v25, 0
    v_mov_b32 v26, 0
    v_mov_b32 v27, 0
    v_mov_b32 v28, 0
    v_mov_b32 v29, 0
    v_mov_b32_e64 v30, 0
    v_mov_b32 v31, 0
    s_mov_b32 s55, 64
L_slow2:
    buffer_load_dwordx4 v[128:131], v15, s[24:27], s56 offen offset:0 sc1
    buffer_load_dwordx4 v[132:135], v15, s[24:27], s56 offen offset:1024 sc1
    buffer_load_dwordx4 v[136:139], v15, s[24:27], s56 offen offset:2048 sc1
    buffer_load_dwordx4 v[140:143], v15, s[24:27], s56 offen offset:3072 sc1
    s_waitcnt vmcnt(0)
    v_mfma_f32_32x32x16_bf16 v[96:111], v[128:131], v[248:251], 0
    v_mfma_f32_32x32x16_bf16 v[96:111], v[132:135], v[252:255], v[96:111]
    s_nop 7
    s_nop 7
    v_sub_f32 v96, v96, v202
    v_sub_f32 v97, v97, v202
    v_sub_f32 v98, v98, v202
    v_sub_f32 v99, v99, v202
    v_sub_f32 v100, v100, v202
    v_sub_f32 v101, v101, v202
    v_sub_f32 v102, v102, v202
    v_sub_f32 v103, v103, v202
    v_sub_f32 v104, v104, v202
    v_sub_f32 v105, v105, v202
    v_sub_f32 v106, v106, v202
    v_sub_f32 v107, v107, v202
    v_sub_f32 v108, v108, v202
    v_sub_f32 v109, v109, v202
    v_sub_f32 v110, v110, v202
    v_sub_f32 v111, v111, v202
    v_exp_f32 v96, v96
    v_exp_f32 v97, v97
    v_exp_f32 v98, v98
    v_exp_f32 v99, v99
    v_exp_f32 v100, v100
    v_exp_f32 v101, v101
    v_exp_f32 v102, v102
    v_exp_f32 v103, v103
    v_exp_f32 v104, v104
    v_exp_f32 v105, v105
    v_exp_f32 v106, v106
    v_exp_f32 v107, v107
    v_exp_f32 v108, v108
    v_exp_f32 v109, v109
    v_exp_f32 v110, v110
    v_exp_f32 v111, v111
    s_nop 0
    v_cvt_pk_bf16_f32 v192, v96, v97
    v_cvt_pk_bf16_f32 v193, v98, v99
    v_cvt_pk_bf16_f32 v194, v100, v101
    v_cvt_pk_bf16_f32 v195, v102, v103
    v_cvt_pk_bf16_f32 v196, v104, v105
    v_cvt_pk_bf16_f32 v197, v106, v107
    v_cvt_pk_bf16_f32 v198, v108, v109
    v_cvt_pk_bf16_f32 v199, v110, v111
    s_nop 1
    v_mfma_f32_32x32x16_bf16 v[16:31], v[136:139], v[192:195], v[16:31]
    v_mfma_f32_32x32x16_bf16 v[16:31], v[140:143], v[196:199], v[16:31]
    s_add_u32 s56, s56, 4096
    s_sub_u32 s55, s55, 1
    s_cmp_lg_u32 s55, 0
    s_cbranch_scc1 L_slow2
    s_nop 7
    s_nop 7
    v_mov_b32 v200, v28
    v_mov_b32 v201, v28
    s_nop 1
    v_permlane32_swap_b32 v200, v201
    s_nop 1
    v_rcp_f32 v200, v201
    s_nop 0
    s_branch L_fin
L_code_end:
.section .rodata,"a"
.p2align 6
.amdhsa_kernel parallel_sum__softmax_full_mha__glu_gated_reglu__prompt_kernel
  .amdhsa_next_free_vgpr 256
  .amdhsa_next_free_sgpr 102
  .amdhsa_accum_offset 256
  .amdhsa_group_segment_fixed_size 0
  .amdhsa_kernarg_size 80
  .amdhsa_user_sgpr_count 2
  .amdhsa_user_sgpr_kernarg_segment_ptr 1
  .amdhsa_system_sgpr_workgroup_id_x 1
.end_amdhsa_kernel
```
